```python
import torch

def _softmax(x, axis=-1):
    return torch.softmax(x, dim=axis)
def _gelu(x):
    return torch.nn.functional.gelu(x, approximate="tanh")
def _silu(x):
    return torch.nn.functional.silu(x)
def _sigmoid(x):
    return torch.sigmoid(x)
def _layernorm(x, axis=-1, eps=1e-5):
    m = x.mean(dim=axis, keepdim=True)
    v = x.var(dim=axis, keepdim=True, unbiased=False)
    return (x - m) / torch.sqrt(v + eps)
def _scatter_add(tgt, idx, src, axis=0):
    return tgt.clone().index_add_(axis, idx, src)
def _segment_sum(src, seg, n):
    out = torch.zeros((n,) + src.shape[1:], dtype=src.dtype)
    return out.index_add_(0, seg, src)
def _pad(x, pw):
    flat = tuple(v for pair in reversed(pw) for v in pair)
    return torch.nn.functional.pad(x, flat)

kernel_name = 'sequential_preLN__linear_attn_block__mixer_channel_mlp__prompt'

def setup_inputs():

    _w = (lambda a: (lambda t: t.to(torch.bfloat16) if t.is_floating_point() else t)(torch.as_tensor(a)))
    def _A_setup():
        B, S, D = 1, 2048, 640
        return {
            "x": _w((lambda *s: torch.randn(*s, dtype=torch.bfloat16) * 0.05)(B, S, D)),
            "wqkv": _w((lambda *s: torch.randn(*s, dtype=torch.bfloat16) * 0.1)(D, 3 * D)),
            "wo": _w((lambda *s: torch.randn(*s, dtype=torch.bfloat16) * 0.05)(D, D)),
        }
    _A_in = _A_setup()

    def _B_setup():
        B, S, D, F = 1, 2048, 640, 1728
        return {
            "x": _w((lambda *s: torch.randn(*s, dtype=torch.bfloat16) * 0.05)(B, S, D)),
            "w1": _w((lambda *s: torch.randn(*s, dtype=torch.bfloat16) * 3.2)(D, F) * (D ** -0.5)),
            "b1": _w((lambda *s: torch.randn(*s, dtype=torch.bfloat16) * 0.8)(F)),
            "w2": _w((lambda *s: torch.randn(*s, dtype=torch.bfloat16) * 0.05)(F, D) * (F ** -0.5)),
            "b2": _w((lambda *s: torch.randn(*s, dtype=torch.bfloat16) * 0.05)(D)),
        }
    _B_in = _B_setup()

    return {
        "A_x": _A_in["x"],
        "A_wqkv": _A_in["wqkv"],
        "A_wo": _A_in["wo"],
        "B_x": _B_in["x"],
        "B_w1": _B_in["w1"],
        "B_b1": _B_in["b1"],
        "B_w2": _B_in["w2"],
        "B_b2": _B_in["b2"],
    }

def reference(A_x, A_wqkv, A_wo, B_x, B_w1, B_b1, B_w2, B_b2):
    def _A_ref(x, wqkv, wo):
        B, S, D = x.shape
        H = 32; Dh = D // H
        qkv = (lambda x, *d: x.permute(*d))((x @ wqkv).reshape(B, S, 3, H, Dh), 2, 0, 3, 1, 4)
        q, k, v = qkv[0], qkv[1], qkv[2]
        phi = lambda t: torch.where(t > 0, t + 1, torch.exp(t)) + 1e-6
        pq, pk = phi(q), phi(k)
        kv = torch.einsum("bhsd,bhse->bhde", pk, v)
        z = torch.einsum("bhsd->bhd", pk)
        num = torch.einsum("bhqd,bhde->bhqe", pq, kv)
        den = torch.einsum("bhqd,bhd->bhq", pq, z)[..., None] + 1e-6
        o = num / den
        return (lambda x, *d: x.permute(*d))(o, 0, 2, 1, 3).reshape(B, S, D) @ wo

    def _B_ref(x, w1, b1, w2, b2):
        y = _layernorm(x, axis=-1)
        h = _gelu(torch.einsum("bsd,df->bsf", y, w1) + b1)
        return torch.einsum("bsf,fd->bsd", h, w2) + b2

    x = A_x
    h = x + _A_ref(_layernorm(x, axis=-1), A_wqkv, A_wo)
    h2 = h + _B_ref(_layernorm(h, axis=-1), B_w1, B_b1, B_w2, B_b2)
    return h2
```

```asm
; @launch grid=(256,1,1) block=(256,1,1) lds=163840
.amdgcn_target "amdgcn-amd-amdhsa--gfx950"
.text
.globl sequential_preLN__linear_attn_block__mixer_channel_mlp__prompt_kernel
.p2align 8
.type sequential_preLN__linear_attn_block__mixer_channel_mlp__prompt_kernel,@function
sequential_preLN__linear_attn_block__mixer_channel_mlp__prompt_kernel:
    s_cmp_ge_u32 s2, 256
    s_cbranch_scc1 L_end
    s_load_dwordx16 s[4:19], s[0:1], 0
    s_load_dwordx4 s[20:23], s[0:1], 64
    s_load_dwordx2 s[24:25], s[0:1], 80
    s_memrealtime s[76:77]
    s_getpc_b64 s[30:31]
L_pc:
    v_mov_b32 v7, 0
    v_lshrrev_b32 v2, 6, v0
    v_and_b32 v1, 63, v0
    v_readfirstlane_b32 s28, v2
    s_and_b32 s3, s2, 7
    s_lshr_b32 s27, s2, 3
    s_lshr_b32 s26, s27, 4
    s_lshl_b32 s3, s3, 1
    s_add_u32 s26, s26, s3
    s_and_b32 s27, s27, 15
    v_lshlrev_b32 v3, 7, v1
    s_cmp_lg_u32 s28, 3
    s_cbranch_scc1 L_nocp
    s_mul_i32 s3, s27, 13
    s_lshr_b32 s3, s3, 6
    s_mul_i32 s3, s3, 5
    s_sub_u32 s3, s27, s3
    s_lshl_b32 s3, s3, 13
    v_add_u32 v27, s3, v3
    global_load_dword v4, v27, s[30:31]
L_nocp:
    v_and_b32 v27, 3, v1
    s_lshl_b32 s3, s28, 2
    v_add_u32 v27, s3, v27
    v_min_u32 v27, 14, v27
    v_lshrrev_b32 v28, 2, v1
    v_mul_u32_u24 v28, 3840, v28
    v_lshl_add_u32 v28, v27, 4, v28
    v_add_u32 v29, 1280, v28
    v_add_u32 v30, 2480, v28
    v_subrev_u32 v28, 160, v28
    v_cmp_gt_u32 vcc, 10, v27
    s_mul_i32 s50, s26, 153600
    s_mul_i32 s51, s27, 80
    v_cndmask_b32 v28, v28, v30, vcc
    v_cmp_gt_u32 vcc, 5, v27
    s_add_u32 s50, s50, s51
    s_mul_i32 s53, s28, 3072
    v_cndmask_b32 v83, v28, v29, vcc
    s_add_u32 s53, s53, 131072
    s_mul_i32 s3, s26, 163840
    s_mul_i32 s56, s27, 10240
    s_add_u32 s3, s3, s56
    s_mul_i32 s56, s28, 2560
    s_add_u32 s57, s3, s56
    v_mov_b32 v5, 0
    s_waitcnt lgkmcnt(0)
    s_mov_b32 s36, s6
    s_and_b32 s37, s7, 0xffff
    s_mov_b32 s38, 2457600
    s_mov_b32 s39, 0x20000
    s_add_u32 m0, s53, 0
    s_nop 0
    buffer_load_dwordx4 v83, s[36:39], s50 offen lds
    s_add_u32 s50, s50, 61440
    s_add_u32 m0, s53, 1024
    s_nop 0
    buffer_load_dwordx4 v83, s[36:39], s50 offen lds
    s_add_u32 s50, s50, 61440
    s_add_u32 m0, s53, 2048
    s_bfm_b64 exec, 32, 0
    buffer_load_dwordx4 v83, s[36:39], s50 offen lds
    s_add_u32 s50, s50, 61440
    s_mov_b32 s32, s4
    s_and_b32 s33, s5, 0xffff
    s_mov_b32 s34, 2621440
    s_mov_b32 s35, 0x20000
    s_mov_b32 s40, s24
    s_and_b32 s41, s25, 0xffff
    s_mov_b32 s42, 21483520
    s_mov_b32 s43, 0x20000
    s_mov_b64 exec, 0xfffff
    buffer_load_dword v4, v3, s[32:35], s57 offen
    s_mov_b64 exec, -1
    s_and_b32 s76, s76, 0xfffffff8
    s_or_b32 s76, s76, 8
    s_or_b32 s3, s2, s28
    s_cmp_lg_u32 s3, 0
    s_cbranch_scc1 L_notag
    v_mov_b32 v28, s76
    global_store_dword v5, v28, s[22:23] sc1
L_notag:
    s_cmp_lg_u32 s26, s27
    s_cbranch_scc1 L_noft
    s_cmp_lg_u32 s28, 1
    s_cbranch_scc1 L_noft
    s_mul_i32 s3, s27, 1280
    s_add_u32 s3, s3, 21463040
    s_bfm_b64 exec, 10, 0
    buffer_load_dword v4, v3, s[40:43], s3 offen sc0 sc1
    s_mov_b64 exec, -1
L_noft:
    s_cmp_lg_u32 s28, 2
    s_cbranch_scc1 L_not3
    v_lshlrev_b32 v27, 16, v1
    v_lshlrev_b32 v28, 18, v1
    s_cmp_lg_u32 s27, 2
    s_cbranch_scc1 L_t3_0
    s_bfm_b64 exec, 34, 0
    global_load_dword v4, v27, s[12:13]
    s_mov_b64 exec, -1
L_t3_0:
    s_cmp_lg_u32 s27, 3
    s_cbranch_scc1 L_t3_1
    s_bfm_b64 exec, 34, 0
    global_load_dword v4, v27, s[16:17]
    s_mov_b64 exec, -1
L_t3_1:
    s_cmp_lg_u32 s27, 4
    s_cbranch_scc1 L_t3_2
    s_bfm_b64 exec, 13, 0
    global_load_dword v4, v27, s[8:9]
    s_mov_b64 exec, -1
L_t3_2:
    s_cmp_lg_u32 s27, 5
    s_cbranch_scc1 L_t3_3
    s_bfm_b64 exec, 40, 0
    global_load_dword v4, v27, s[20:21]
    s_mov_b64 exec, -1
L_t3_3:
    s_cmp_lg_u32 s27, 6
    s_cbranch_scc1 L_t3_4
    buffer_load_dword v4, v28, s[40:43], 0 offen
L_t3_4:
    s_cmp_lg_u32 s27, 7
    s_cbranch_scc1 L_not3
    s_mov_b32 s3, 16777216
    buffer_load_dword v4, v28, s[40:43], s3 offen
L_not3:
    s_lshl_b32 s3, s27, 2
    s_add_u32 s3, s3, s28
    s_cmp_lg_u32 s3, 6
    s_cbranch_scc1 L_nobt
    s_bfm_b64 exec, 27, 0
    global_load_dword v4, v3, s[14:15]
    s_bfm_b64 exec, 10, 0
    global_load_dword v4, v3, s[18:19]
    s_mov_b64 exec, -1
L_nobt:
    s_mov_b32 s44, s12
    s_and_b32 s45, s13, 0xffff
    s_mov_b32 s46, 2211840
    s_mov_b32 s47, 0x20000
    v_lshlrev_b32 v8, 4, v1
    v_lshlrev_b32 v9, 4, v0
    v_and_b32 v10, 15, v1
    v_lshlrev_b32 v10, 2, v10
    v_lshrrev_b32 v11, 4, v1
    v_add_u32 v12, 4096, v8
    v_lshrrev_b32 v27, 3, v1
    v_and_b32 v28, 7, v1
    v_mul_u32_u24 v29, 1280, v27
    v_lshrrev_b32 v30, 1, v27
    v_xor_b32 v28, v28, v30
    v_lshl_add_u32 v72, v28, 4, v29
    v_xor_b32 v73, 64, v72
    v_add_u32 v73, 10240, v73
    v_add_u32 v74, 20480, v72
    v_add_u32 v75, 20480, v73
    s_lshl_b32 s3, s28, 11
    s_add_u32 s48, s3, 153600
    s_lshl_b32 s49, s26, 7
    s_lshl_b32 s3, s28, 5
    s_add_u32 s49, s49, s3
    s_mul_i32 s49, s49, 1280
    s_lshr_b32 s3, s28, 1
    s_lshl_b32 s3, s3, 7
    s_add_u32 s62, s49, 128
    s_sub_u32 s62, s62, s3
    s_add_u32 s49, s49, s3
    s_mul_i32 s52, s28, 5120
    s_mul_i32 s58, s26, 779264
    s_add_u32 s58, s58, 8994816
    s_lshl_b32 s70, s28, 4
    s_add_u32 s70, s70, s26
    s_mul_i32 s71, s28, 7168
    s_add_u32 s71, s71, 102400
    v_mov_b32 v2, 0x7fffffff
    v_and_b32 v27, 15, v1
    v_cmp_gt_u32 s[66:67], 8, v27
    v_cmp_gt_u32 s[90:91], 32, v1
    v_cmp_gt_u32 s[92:93], 48, v1
    v_cmp_eq_u32 s[88:89], 1, v11
    v_and_b32 v29, 1, v11
    s_lshl_b32 s3, s28, 1
    v_add_u32 v29, s3, v29
    v_cmp_gt_u32 s[94:95], 5, v29
    v_cmp_eq_u32 s[96:97], 7, v29
    v_lshlrev_b32 v29, 10, v29
    v_add_u32 v30, 97280, v29
    v_cndmask_b32 v29, v30, v29, s[94:95]
    v_lshl_add_u32 v29, v10, 2, v29
    v_mov_b32 v30, 2560
    v_mov_b32 v31, 5120
    v_cndmask_b32 v30, v30, v31, s[94:95]
    v_mov_b32 v31, 8
    v_cndmask_b32 v31, v31, 7, s[96:97]
    s_andn2_b64 s[96:97], s[96:97], s[66:67]
    s_mul_i32 s3, s26, 5
    v_lshrrev_b32 v28, 1, v11
    v_add_u32 v28, s3, v28
    v_lshrrev_b32 v27, 2, v28
    v_mad_u32_u24 v80, v27, v30, v29
    v_and_b32 v27, 3, v28
    v_lshlrev_b32 v27, v31, v27
    v_add_u32 v80, v80, v27
    v_cndmask_b32 v80, v80, v2, s[96:97]
    v_add_u32 v28, 2, v28
    v_lshrrev_b32 v27, 2, v28
    v_mad_u32_u24 v81, v27, v30, v29
    v_and_b32 v27, 3, v28
    v_lshlrev_b32 v27, v31, v27
    v_add_u32 v81, v81, v27
    v_cndmask_b32 v81, v81, v2, s[96:97]
    v_add_u32 v28, 2, v28
    v_lshrrev_b32 v27, 2, v28
    v_mad_u32_u24 v82, v27, v30, v29
    v_and_b32 v27, 3, v28
    v_lshlrev_b32 v27, v31, v27
    v_add_u32 v82, v82, v27
    v_cndmask_b32 v82, v82, v2, s[96:97]
    v_cndmask_b32 v82, v2, v82, s[90:91]
    v_lshrrev_b32 v27, 5, v1
    v_bfe_u32 v28, v1, 2, 2
    v_lshl_add_u32 v27, v27, 3, v28
    v_lshlrev_b32 v27, 6, v27
    v_bfe_u32 v28, v1, 4, 1
    v_lshl_add_u32 v27, v28, 5, v27
    v_and_b32 v28, 3, v1
    v_lshl_add_u32 v27, v28, 3, v27
    v_add_u32 v84, s53, v27
    s_mul_i32 s54, s27, 153600
    s_add_u32 s54, s54, 5488640
    s_waitcnt vmcnt(1)
    ds_read_b64_tr_b16 v[96:97], v84 offset:0
    ds_read_b64_tr_b16 v[98:99], v84 offset:256
    ds_read_b64_tr_b16 v[100:101], v84 offset:1024
    ds_read_b64_tr_b16 v[102:103], v84 offset:1280
    ds_read_b64_tr_b16 v[104:105], v84 offset:2048
    ds_read_b64_tr_b16 v[106:107], v84 offset:2304
    s_waitcnt lgkmcnt(0)
    buffer_store_dwordx4 v[96:99], v80, s[40:43], s54 offen sc1
    buffer_store_dwordx4 v[100:103], v81, s[40:43], s54 offen sc1
    buffer_store_dwordx4 v[104:107], v82, s[40:43], s54 offen sc1
    global_load_dword v6, v5, s[22:23] sc1
    s_add_u32 m0, s52, 1024
    s_nop 0
    buffer_load_dwordx4 v72, s[32:35], s49 offen offset:0 lds
    s_add_u32 m0, s52, 2048
    s_nop 0
    buffer_load_dwordx4 v73, s[32:35], s49 offen offset:0 lds
    s_add_u32 m0, s52, 3072
    s_nop 0
    buffer_load_dwordx4 v74, s[32:35], s49 offen offset:0 lds
    s_add_u32 m0, s52, 4096
    s_nop 0
    buffer_load_dwordx4 v75, s[32:35], s49 offen offset:0 lds
    s_add_u32 m0, s52, 21504
    s_nop 0
    buffer_load_dwordx4 v72, s[32:35], s62 offen offset:0 lds
    s_add_u32 m0, s52, 22528
    s_nop 0
    buffer_load_dwordx4 v73, s[32:35], s62 offen offset:0 lds
    s_add_u32 m0, s52, 23552
    s_nop 0
    buffer_load_dwordx4 v74, s[32:35], s62 offen offset:0 lds
    s_add_u32 m0, s52, 24576
    s_nop 0
    buffer_load_dwordx4 v75, s[32:35], s62 offen offset:0 lds
    s_add_u32 m0, s52, 41728
    s_nop 0
    buffer_load_dwordx4 v72, s[32:35], s49 offen offset:256 lds
    s_add_u32 m0, s52, 42752
    s_nop 0
    buffer_load_dwordx4 v73, s[32:35], s49 offen offset:256 lds
    s_add_u32 m0, s52, 43776
    s_nop 0
    buffer_load_dwordx4 v74, s[32:35], s49 offen offset:256 lds
    s_add_u32 m0, s52, 44800
    s_nop 0
    buffer_load_dwordx4 v75, s[32:35], s49 offen offset:256 lds
    v_and_b32 v27, 15, v1
    v_lshrrev_b32 v29, 1, v27
    v_xor_b32 v29, v29, v11
    v_lshlrev_b32 v29, 4, v29
    v_lshl_add_u32 v29, v27, 7, v29
    s_and_b32 s3, s28, 1
    s_lshl_b32 s3, s3, 6
    v_xor_b32 v29, s3, v29
    v_add_u32 v78, s52, v29
    v_xor_b32 v29, 64, v29
    v_add_u32 v79, s52, v29
    v_add_u32 v76, 61440, v78
    v_add_u32 v77, 61440, v79
    v_lshrrev_b32 v29, 2, v27
    v_cmp_eq_u32 vcc, v29, v11
    v_lshlrev_b32 v30, 2, v1
    v_add_u32 v30, 512, v30
    v_cndmask_b32 v29, v30, v10, vcc
    v_add_u32 v25, s48, v29
    v_and_b32 v29, 1, v1
    v_cmp_eq_u32 s[68:69], 1, v29
    v_and_b32 v29, 2, v1
    v_cmp_eq_u32 s[86:87], 2, v29
    v_mov_b32 v28, 0x3f803f80
    v_accvgpr_write_b32 a200, v28
    v_accvgpr_write_b32 a201, v28
    v_accvgpr_write_b32 a202, v28
    v_accvgpr_write_b32 a203, v28
    v_cmp_eq_u32 vcc, 0, v27
    s_nop 1
    v_cndmask_b32 v29, 0, v28, vcc
    v_accvgpr_write_b32 a220, v29
    v_accvgpr_write_b32 a221, v29
    v_accvgpr_write_b32 a222, v29
    v_accvgpr_write_b32 a223, v29
    v_cmp_eq_u32 vcc, 1, v27
    s_nop 1
    v_cndmask_b32 v29, 0, v28, vcc
    v_accvgpr_write_b32 a224, v29
    v_accvgpr_write_b32 a225, v29
    v_accvgpr_write_b32 a226, v29
    v_accvgpr_write_b32 a227, v29
    v_cmp_eq_u32 vcc, 2, v27
    s_nop 1
    v_cndmask_b32 v29, 0, v28, vcc
    v_accvgpr_write_b32 a228, v29
    v_accvgpr_write_b32 a229, v29
    v_accvgpr_write_b32 a230, v29
    v_accvgpr_write_b32 a231, v29
    v_cmp_eq_u32 vcc, 3, v27
    s_nop 1
    v_cndmask_b32 v29, 0, v28, vcc
    v_accvgpr_write_b32 a232, v29
    v_accvgpr_write_b32 a233, v29
    v_accvgpr_write_b32 a234, v29
    v_accvgpr_write_b32 a235, v29
    v_cmp_eq_u32 vcc, 4, v27
    s_nop 1
    v_cndmask_b32 v29, 0, v28, vcc
    v_accvgpr_write_b32 a236, v29
    v_accvgpr_write_b32 a237, v29
    v_accvgpr_write_b32 a238, v29
    v_accvgpr_write_b32 a239, v29
    v_and_b32 v27, 7, v1
    v_lshlrev_b32 v27, 4, v27
    v_lshl_add_u32 v27, v11, 7, v27
    s_xor_b32 s3, s28, 0
    s_mul_i32 s56, s3, 5120
    v_add_u32 v17, s56, v8
    s_mul_i32 s56, s3, 2560
    s_add_u32 s56, s56, 102400
    v_add_u32 v86, s56, v8
    s_add_u32 s56, s56, 2048
    v_add_u32 v90, s56, v27
    s_xor_b32 s3, s28, 1
    s_mul_i32 s56, s3, 5120
    v_add_u32 v18, s56, v8
    s_mul_i32 s56, s3, 2560
    s_add_u32 s56, s56, 102400
    v_add_u32 v87, s56, v8
    s_add_u32 s56, s56, 2048
    v_add_u32 v91, s56, v27
    s_xor_b32 s3, s28, 2
    s_mul_i32 s56, s3, 5120
    v_add_u32 v19, s56, v8
    s_mul_i32 s56, s3, 2560
    s_add_u32 s56, s56, 102400
    v_add_u32 v88, s56, v8
    s_add_u32 s56, s56, 2048
    v_add_u32 v21, s56, v27
    s_xor_b32 s3, s28, 3
    s_mul_i32 s56, s3, 5120
    v_add_u32 v20, s56, v8
    s_mul_i32 s56, s3, 2560
    s_add_u32 s56, s56, 102400
    v_add_u32 v89, s56, v8
    s_add_u32 s56, s56, 2048
    v_add_u32 v22, s56, v27
    s_mov_b32 s60, 0x3fb8aa3b
    s_mov_b32 s61, 0x358637bd
    s_mov_b32 s63, 0x3acccccd
    s_mov_b32 s64, 0x3727c5ac
    s_lshl_b32 s55, s27, 8
    s_add_u32 s55, s55, 21473280
    v_lshlrev_b32 v26, 2, v1
    s_lshl_b32 s3, s26, 4
    s_lshl_b32 s56, s28, 2
    s_add_u32 s3, s3, s56
    s_add_u32 s3, s3, s55
    s_waitcnt vmcnt(12)
    v_readfirstlane_b32 s76, v6
    s_mov_b32 s78, 0
L_tp1:
    s_cmp_lg_u32 s76, 0
    s_cbranch_scc1 L_tp1_ok
    global_load_dword v6, v5, s[22:23] sc1
    s_add_u32 s78, s78, 1
    s_waitcnt vmcnt(0)
    v_readfirstlane_b32 s76, v6
    s_cmp_lt_u32 s78, 32768
    s_cbranch_scc1 L_tp1
L_tp1_ok:
    s_getreg_b32 s77, hwreg(HW_REG_XCC_ID)
    s_and_b32 s77, s77, 7
    s_or_b32 s77, s77, s76
    s_lshl_b32 s57, s26, 7
    s_lshl_b32 s56, s27, 2
    s_add_u32 s57, s57, s56
    s_add_u32 s57, s57, 21471232
    s_cmp_eq_u32 s28, 0
    s_cselect_b32 s57, s57, 0x40000000
    v_mov_b32 v27, s77
    s_mov_b64 exec, 1
    buffer_store_dword v6, v5, s[40:43], s3 offen sc1
    buffer_store_dword v27, v5, s[40:43], s57 offen sc1
    s_mov_b64 exec, -1
    s_add_u32 m0, s52, 62208
    s_nop 0
    buffer_load_dwordx4 v72, s[32:35], s62 offen offset:256 lds
    s_add_u32 m0, s52, 63232
    s_nop 0
    buffer_load_dwordx4 v73, s[32:35], s62 offen offset:256 lds
    s_add_u32 m0, s52, 64256
    s_nop 0
    buffer_load_dwordx4 v74, s[32:35], s62 offen offset:256 lds
    s_add_u32 m0, s52, 65280
    s_nop 0
    buffer_load_dwordx4 v75, s[32:35], s62 offen offset:256 lds
    s_add_u32 m0, s52, 82432
    s_nop 0
    buffer_load_dwordx4 v72, s[32:35], s49 offen offset:512 lds
    s_add_u32 m0, s52, 83456
    s_nop 0
    buffer_load_dwordx4 v73, s[32:35], s49 offen offset:512 lds
    s_add_u32 m0, s52, 84480
    s_nop 0
    buffer_load_dwordx4 v74, s[32:35], s49 offen offset:512 lds
    s_add_u32 m0, s52, 85504
    s_nop 0
    buffer_load_dwordx4 v75, s[32:35], s49 offen offset:512 lds
    s_waitcnt vmcnt(18)
    ds_read_b128 a[0:3], v78 offset:1024
    ds_read_b128 a[4:7], v79 offset:1024
    ds_read_b128 a[80:83], v78 offset:3072
    ds_read_b128 a[84:87], v79 offset:3072
    s_waitcnt vmcnt(14)
    ds_read_b128 a[8:11], v78 offset:21504
    ds_read_b128 a[12:15], v79 offset:21504
    ds_read_b128 a[88:91], v78 offset:23552
    ds_read_b128 a[92:95], v79 offset:23552
    s_waitcnt lgkmcnt(4)
    v_mfma_f32_16x16x32_bf16 a[204:207], a[0:3], a[0:3], 0
    s_add_u32 m0, s52, 512
    s_nop 0
    buffer_load_dwordx4 v72, s[32:35], s62 offen offset:512 lds
    v_mfma_f32_16x16x32_bf16 a[212:215], a[200:203], a[0:3], 0
    v_mfma_f32_16x16x32_bf16 a[208:211], a[80:83], a[80:83], 0
    s_add_u32 m0, s52, 1536
    s_nop 0
    buffer_load_dwordx4 v73, s[32:35], s62 offen offset:512 lds
    v_mfma_f32_16x16x32_bf16 a[216:219], a[200:203], a[80:83], 0
    v_mfma_f32_16x16x32_bf16 a[204:207], a[4:7], a[4:7], a[204:207]
    s_add_u32 m0, s52, 2560
    s_nop 0
    buffer_load_dwordx4 v74, s[32:35], s62 offen offset:512 lds
    v_mfma_f32_16x16x32_bf16 a[212:215], a[200:203], a[4:7], a[212:215]
    v_mfma_f32_16x16x32_bf16 a[208:211], a[84:87], a[84:87], a[208:211]
    s_add_u32 m0, s52, 3584
    s_nop 0
    buffer_load_dwordx4 v75, s[32:35], s62 offen offset:512 lds
    v_mfma_f32_16x16x32_bf16 a[216:219], a[200:203], a[84:87], a[216:219]
    s_waitcnt vmcnt(14)
    ds_read_b128 a[16:19], v78 offset:41984
    ds_read_b128 a[20:23], v79 offset:41984
    ds_read_b128 a[96:99], v78 offset:44032
    ds_read_b128 a[100:103], v79 offset:44032
    s_waitcnt lgkmcnt(4)
    v_mfma_f32_16x16x32_bf16 a[204:207], a[8:11], a[8:11], a[204:207]
    s_add_u32 m0, s52, 20736
    s_nop 0
    buffer_load_dwordx4 v72, s[32:35], s49 offen offset:768 lds
    v_mfma_f32_16x16x32_bf16 a[212:215], a[200:203], a[8:11], a[212:215]
    v_mfma_f32_16x16x32_bf16 a[208:211], a[88:91], a[88:91], a[208:211]
    s_add_u32 m0, s52, 21760
    s_nop 0
    buffer_load_dwordx4 v73, s[32:35], s49 offen offset:768 lds
    v_mfma_f32_16x16x32_bf16 a[216:219], a[200:203], a[88:91], a[216:219]
    v_mfma_f32_16x16x32_bf16 a[204:207], a[12:15], a[12:15], a[204:207]
    s_add_u32 m0, s52, 22784
    s_nop 0
    buffer_load_dwordx4 v74, s[32:35], s49 offen offset:768 lds
    v_mfma_f32_16x16x32_bf16 a[212:215], a[200:203], a[12:15], a[212:215]
    v_mfma_f32_16x16x32_bf16 a[208:211], a[92:95], a[92:95], a[208:211]
    s_add_u32 m0, s52, 23808
    s_nop 0
    buffer_load_dwordx4 v75, s[32:35], s49 offen offset:768 lds
    v_mfma_f32_16x16x32_bf16 a[216:219], a[200:203], a[92:95], a[216:219]
    s_waitcnt vmcnt(12)
    ds_read_b128 a[24:27], v76 offset:1024
    ds_read_b128 a[28:31], v77 offset:1024
    ds_read_b128 a[104:107], v76 offset:3072
    ds_read_b128 a[108:111], v77 offset:3072
    s_waitcnt lgkmcnt(4)
    v_mfma_f32_16x16x32_bf16 a[204:207], a[16:19], a[16:19], a[204:207]
    s_add_u32 m0, s52, 41216
    s_nop 0
    buffer_load_dwordx4 v72, s[32:35], s62 offen offset:768 lds
    v_mfma_f32_16x16x32_bf16 a[212:215], a[200:203], a[16:19], a[212:215]
    v_mfma_f32_16x16x32_bf16 a[208:211], a[96:99], a[96:99], a[208:211]
    s_add_u32 m0, s52, 42240
    s_nop 0
    buffer_load_dwordx4 v73, s[32:35], s62 offen offset:768 lds
    v_mfma_f32_16x16x32_bf16 a[216:219], a[200:203], a[96:99], a[216:219]
    v_mfma_f32_16x16x32_bf16 a[204:207], a[20:23], a[20:23], a[204:207]
    s_add_u32 m0, s52, 43264
    s_nop 0
    buffer_load_dwordx4 v74, s[32:35], s62 offen offset:768 lds
    v_mfma_f32_16x16x32_bf16 a[212:215], a[200:203], a[20:23], a[212:215]
    v_mfma_f32_16x16x32_bf16 a[208:211], a[100:103], a[100:103], a[208:211]
    s_add_u32 m0, s52, 44288
    s_nop 0
    buffer_load_dwordx4 v75, s[32:35], s62 offen offset:768 lds
    v_mfma_f32_16x16x32_bf16 a[216:219], a[200:203], a[100:103], a[216:219]
    s_waitcnt vmcnt(12)
    ds_read_b128 a[32:35], v76 offset:21504
    ds_read_b128 a[36:39], v77 offset:21504
    ds_read_b128 a[112:115], v76 offset:23552
    ds_read_b128 a[116:119], v77 offset:23552
    s_waitcnt lgkmcnt(4)
    v_mfma_f32_16x16x32_bf16 a[204:207], a[24:27], a[24:27], a[204:207]
    s_add_u32 m0, s52, 61440
    s_nop 0
    buffer_load_dwordx4 v72, s[32:35], s49 offen offset:1024 lds
    v_mfma_f32_16x16x32_bf16 a[212:215], a[200:203], a[24:27], a[212:215]
    v_mfma_f32_16x16x32_bf16 a[208:211], a[104:107], a[104:107], a[208:211]
    s_add_u32 m0, s52, 62464
    s_nop 0
    buffer_load_dwordx4 v73, s[32:35], s49 offen offset:1024 lds
    v_mfma_f32_16x16x32_bf16 a[216:219], a[200:203], a[104:107], a[216:219]
    v_mfma_f32_16x16x32_bf16 a[204:207], a[28:31], a[28:31], a[204:207]
    s_add_u32 m0, s52, 63488
    s_nop 0
    buffer_load_dwordx4 v74, s[32:35], s49 offen offset:1024 lds
    v_mfma_f32_16x16x32_bf16 a[212:215], a[200:203], a[28:31], a[212:215]
    v_mfma_f32_16x16x32_bf16 a[208:211], a[108:111], a[108:111], a[208:211]
    s_add_u32 m0, s52, 64512
    s_nop 0
    buffer_load_dwordx4 v75, s[32:35], s49 offen offset:1024 lds
    v_mfma_f32_16x16x32_bf16 a[216:219], a[200:203], a[108:111], a[216:219]
    s_waitcnt vmcnt(12)
    ds_read_b128 a[40:43], v78 offset:1024
    ds_read_b128 a[44:47], v79 offset:1024
    ds_read_b128 a[120:123], v78 offset:3072
    ds_read_b128 a[124:127], v79 offset:3072
    s_waitcnt lgkmcnt(4)
    v_mfma_f32_16x16x32_bf16 a[204:207], a[32:35], a[32:35], a[204:207]
    s_add_u32 m0, s52, 81920
    s_nop 0
    buffer_load_dwordx4 v72, s[32:35], s62 offen offset:1024 lds
    v_mfma_f32_16x16x32_bf16 a[212:215], a[200:203], a[32:35], a[212:215]
    v_mfma_f32_16x16x32_bf16 a[208:211], a[112:115], a[112:115], a[208:211]
    s_add_u32 m0, s52, 82944
    s_nop 0
    buffer_load_dwordx4 v73, s[32:35], s62 offen offset:1024 lds
    v_mfma_f32_16x16x32_bf16 a[216:219], a[200:203], a[112:115], a[216:219]
    v_mfma_f32_16x16x32_bf16 a[204:207], a[36:39], a[36:39], a[204:207]
    s_add_u32 m0, s52, 83968
    s_nop 0
    buffer_load_dwordx4 v74, s[32:35], s62 offen offset:1024 lds
    v_mfma_f32_16x16x32_bf16 a[212:215], a[200:203], a[36:39], a[212:215]
    v_mfma_f32_16x16x32_bf16 a[208:211], a[116:119], a[116:119], a[208:211]
    s_add_u32 m0, s52, 84992
    s_nop 0
    buffer_load_dwordx4 v75, s[32:35], s62 offen offset:1024 lds
    v_mfma_f32_16x16x32_bf16 a[216:219], a[200:203], a[116:119], a[216:219]
    s_waitcnt vmcnt(12)
    ds_read_b128 a[48:51], v78 offset:21504
    ds_read_b128 a[52:55], v79 offset:21504
    ds_read_b128 a[128:131], v78 offset:23552
    ds_read_b128 a[132:135], v79 offset:23552
    s_waitcnt lgkmcnt(4)
    v_mfma_f32_16x16x32_bf16 a[204:207], a[40:43], a[40:43], a[204:207]
    v_lshlrev_b32 v27, 1, v0
    s_add_u32 s56, s30, T1_tab-L_pc
    s_addc_u32 s57, s31, 0
    global_load_ushort v24, v27, s[56:57]
    v_mfma_f32_16x16x32_bf16 a[212:215], a[200:203], a[40:43], a[212:215]
    v_mfma_f32_16x16x32_bf16 a[208:211], a[120:123], a[120:123], a[208:211]
    s_add_u32 s3, s58, 335872
    s_bfm_b64 exec, 8, 0
    buffer_load_dword v4, v3, s[40:43], s3 offen
    s_mov_b64 exec, -1
    v_mfma_f32_16x16x32_bf16 a[216:219], a[200:203], a[120:123], a[216:219]
    v_mfma_f32_16x16x32_bf16 a[204:207], a[44:47], a[44:47], a[204:207]
    v_mfma_f32_16x16x32_bf16 a[212:215], a[200:203], a[44:47], a[212:215]
    s_cmp_ge_u32 s70, 20
    s_cbranch_scc1 L_rp5
    s_mov_b32 s72, 1
    s_mul_i32 s75, s27, 27
    s_lshr_b32 s75, s75, 2
    s_lshl_b32 s75, s75, 5
    s_mul_i32 s79, s70, 110592
    s_add_u32 s73, s75, s79
    s_mul_i32 s75, s27, 20
    s_add_u32 s70, s70, s75
    s_mul_i32 s74, s70, 7168
    s_add_u32 s74, s74, 3031040
    v_add_u32 v27, 0, v1
    v_mul_u32_u24 v28, 4682, v27
    v_lshrrev_b32 v28, 16, v28
    v_mul_u32_u24 v29, 14, v28
    v_sub_u32 v29, v27, v29
    v_mul_u32_u24 v28, 3456, v28
    v_lshl_add_u32 v28, v29, 4, v28
    s_add_u32 m0, s71, 0
    s_nop 0
    buffer_load_dwordx4 v28, s[44:47], s73 offen lds
    v_add_u32 v27, 64, v1
    v_mul_u32_u24 v28, 4682, v27
    v_lshrrev_b32 v28, 16, v28
    v_mul_u32_u24 v29, 14, v28
    v_sub_u32 v29, v27, v29
    v_mul_u32_u24 v28, 3456, v28
    v_lshl_add_u32 v28, v29, 4, v28
    s_add_u32 m0, s71, 1024
    s_nop 0
    buffer_load_dwordx4 v28, s[44:47], s73 offen lds
    v_add_u32 v27, 128, v1
    v_mul_u32_u24 v28, 4682, v27
    v_lshrrev_b32 v28, 16, v28
    v_mul_u32_u24 v29, 14, v28
    v_sub_u32 v29, v27, v29
    v_mul_u32_u24 v28, 3456, v28
    v_lshl_add_u32 v28, v29, 4, v28
    s_add_u32 m0, s71, 2048
    s_nop 0
    buffer_load_dwordx4 v28, s[44:47], s73 offen lds
    v_add_u32 v27, 192, v1
    v_mul_u32_u24 v28, 4682, v27
    v_lshrrev_b32 v28, 16, v28
    v_mul_u32_u24 v29, 14, v28
    v_sub_u32 v29, v27, v29
    v_mul_u32_u24 v28, 3456, v28
    v_lshl_add_u32 v28, v29, 4, v28
    s_add_u32 m0, s71, 3072
    s_nop 0
    buffer_load_dwordx4 v28, s[44:47], s73 offen lds
    v_add_u32 v27, 256, v1
    v_mul_u32_u24 v28, 4682, v27
    v_lshrrev_b32 v28, 16, v28
    v_mul_u32_u24 v29, 14, v28
    v_sub_u32 v29, v27, v29
    v_mul_u32_u24 v28, 3456, v28
    v_lshl_add_u32 v28, v29, 4, v28
    s_add_u32 m0, s71, 4096
    s_nop 0
    buffer_load_dwordx4 v28, s[44:47], s73 offen lds
    v_add_u32 v27, 320, v1
    v_mul_u32_u24 v28, 4682, v27
    v_lshrrev_b32 v28, 16, v28
    v_mul_u32_u24 v29, 14, v28
    v_sub_u32 v29, v27, v29
    v_mul_u32_u24 v28, 3456, v28
    v_lshl_add_u32 v28, v29, 4, v28
    s_add_u32 m0, s71, 5120
    s_nop 0
    buffer_load_dwordx4 v28, s[44:47], s73 offen lds
    v_add_u32 v27, 384, v1
    v_mul_u32_u24 v28, 4682, v27
    v_lshrrev_b32 v28, 16, v28
    v_mul_u32_u24 v29, 14, v28
    v_sub_u32 v29, v27, v29
    v_mul_u32_u24 v28, 3456, v28
    v_lshl_add_u32 v28, v29, 4, v28
    s_add_u32 m0, s71, 6144
    s_nop 0
    buffer_load_dwordx4 v28, s[44:47], s73 offen lds
    s_branch L_rp_issued
L_rp5:
    s_mov_b32 s72, 2
    s_sub_u32 s79, s70, 20
    s_lshl_b32 s79, s79, 1
    s_lshr_b32 s75, s27, 3
    s_add_u32 s79, s79, s75
    s_and_b32 s75, s27, 7
    s_cmp_ge_u32 s79, 54
    s_cbranch_scc1 L_rpwo
    s_mov_b32 s44, s16
    s_and_b32 s45, s17, 0xffff
    s_mov_b32 s46, 2211840
    s_mov_b32 s47, 0x20000
    s_mul_i32 s78, s75, 54
    s_add_u32 s78, s78, s79
    s_mul_i32 s74, s78, 5120
    s_add_u32 s74, s74, 819200
    s_mov_b32 s83, 0
    s_cmp_ge_u32 s79, 48
    s_cbranch_scc1 L_w2s
    s_lshr_b32 s84, s79, 1
    s_and_b32 s85, s79, 1
    s_lshl_b32 s85, s85, 1
    s_sub_u32 s78, s79, 32
    s_cmp_ge_u32 s79, 32
    s_cselect_b32 s84, s78, s84
    s_cselect_b32 s85, 4, s85
    s_mul_i32 s84, s84, 27
    s_lshr_b32 s84, s84, 2
    s_add_u32 s79, s84, s85
    s_branch L_rp5b
L_w2s:
    s_sub_u32 s84, s79, 48
    s_lshl_b32 s84, s84, 1
    s_add_u32 s85, s84, 1
    s_mul_i32 s78, s84, 11
    s_lshr_b32 s78, s78, 5
    s_add_u32 s84, s84, s78
    s_add_u32 s84, s84, 1
    s_mul_i32 s84, s84, 27
    s_lshr_b32 s84, s84, 2
    s_mul_i32 s78, s85, 11
    s_lshr_b32 s78, s78, 5
    s_add_u32 s85, s85, s78
    s_add_u32 s85, s85, 1
    s_mul_i32 s85, s85, 27
    s_lshr_b32 s85, s85, 2
    s_add_u32 s79, s84, 6
    s_sub_u32 s83, s85, s84
    s_sub_u32 s83, s83, 1
    s_lshl_b32 s83, s83, 4
    s_branch L_rp5b
L_rpwo:
    s_mov_b32 s44, s8
    s_and_b32 s45, s9, 0xffff
    s_mov_b32 s46, 819200
    s_mov_b32 s47, 0x20000
    s_sub_u32 s79, s79, 54
    s_mul_i32 s78, s75, 20
    s_add_u32 s78, s78, s79
    s_mul_i32 s74, s78, 5120
    s_add_u32 s74, s74, 0
    s_cmp_ge_u32 s79, 20
    s_cselect_b32 s74, 0x40000000, s74
    s_lshl_b32 s79, s79, 1
    s_mov_b32 s83, 0
L_rp5b:
    s_mul_i32 s75, s75, 160
    s_mul_i32 s79, s79, 20480
    s_add_u32 s73, s75, s79
    v_add_u32 v27, 0, v1
    v_mul_u32_u24 v28, 6554, v27
    v_lshrrev_b32 v28, 16, v28
    v_mul_u32_u24 v29, 10, v28
    v_sub_u32 v29, v27, v29
    v_cmp_lt_u32 vcc, 15, v28
    v_add_u32 v30, s83, v28
    s_nop 0
    v_cndmask_b32 v28, v28, v30, vcc
    v_mul_u32_u24 v28, 1280, v28
    v_lshl_add_u32 v28, v29, 4, v28
    s_add_u32 m0, s71, 0
    s_nop 0
    buffer_load_dwordx4 v28, s[44:47], s73 offen lds
    v_add_u32 v27, 64, v1
    v_mul_u32_u24 v28, 6554, v27
    v_lshrrev_b32 v28, 16, v28
    v_mul_u32_u24 v29, 10, v28
    v_sub_u32 v29, v27, v29
    v_cmp_lt_u32 vcc, 15, v28
    v_add_u32 v30, s83, v28
    s_nop 0
    v_cndmask_b32 v28, v28, v30, vcc
    v_mul_u32_u24 v28, 1280, v28
    v_lshl_add_u32 v28, v29, 4, v28
    s_add_u32 m0, s71, 1024
    s_nop 0
    buffer_load_dwordx4 v28, s[44:47], s73 offen lds
    v_add_u32 v27, 128, v1
    v_mul_u32_u24 v28, 6554, v27
    v_lshrrev_b32 v28, 16, v28
    v_mul_u32_u24 v29, 10, v28
    v_sub_u32 v29, v27, v29
    v_cmp_lt_u32 vcc, 15, v28
    v_add_u32 v30, s83, v28
    s_nop 0
    v_cndmask_b32 v28, v28, v30, vcc
    v_mul_u32_u24 v28, 1280, v28
    v_lshl_add_u32 v28, v29, 4, v28
    s_add_u32 m0, s71, 2048
    s_nop 0
    buffer_load_dwordx4 v28, s[44:47], s73 offen lds
    v_add_u32 v27, 192, v1
    v_mul_u32_u24 v28, 6554, v27
    v_lshrrev_b32 v28, 16, v28
    v_mul_u32_u24 v29, 10, v28
    v_sub_u32 v29, v27, v29
    v_cmp_lt_u32 vcc, 15, v28
    v_add_u32 v30, s83, v28
    s_nop 0
    v_cndmask_b32 v28, v28, v30, vcc
    v_mul_u32_u24 v28, 1280, v28
    v_lshl_add_u32 v28, v29, 4, v28
    s_add_u32 m0, s71, 3072
    s_nop 0
    buffer_load_dwordx4 v28, s[44:47], s73 offen lds
    v_add_u32 v27, 256, v1
    v_mul_u32_u24 v28, 6554, v27
    v_lshrrev_b32 v28, 16, v28
    v_mul_u32_u24 v29, 10, v28
    v_sub_u32 v29, v27, v29
    v_cmp_lt_u32 vcc, 15, v28
    v_add_u32 v30, s83, v28
    s_nop 0
    v_cndmask_b32 v28, v28, v30, vcc
    v_mul_u32_u24 v28, 1280, v28
    v_lshl_add_u32 v28, v29, 4, v28
    s_add_u32 m0, s71, 4096
    s_nop 0
    buffer_load_dwordx4 v28, s[44:47], s73 offen lds
    buffer_load_dword v4, v2, s[44:47], 0 offen
    buffer_load_dword v4, v2, s[44:47], 0 offen
L_rp_issued:
    v_mfma_f32_16x16x32_bf16 a[208:211], a[124:127], a[124:127], a[208:211]
    v_mfma_f32_16x16x32_bf16 a[216:219], a[200:203], a[124:127], a[216:219]
    s_waitcnt vmcnt(17)
    ds_read_b128 a[56:59], v78 offset:41984
    ds_read_b128 a[60:63], v79 offset:41984
    ds_read_b128 a[136:139], v78 offset:44032
    ds_read_b128 a[140:143], v79 offset:44032
    s_waitcnt lgkmcnt(4)
    v_mfma_f32_16x16x32_bf16 a[204:207], a[48:51], a[48:51], a[204:207]
    v_mfma_f32_16x16x32_bf16 a[212:215], a[200:203], a[48:51], a[212:215]
    v_mfma_f32_16x16x32_bf16 a[208:211], a[128:131], a[128:131], a[208:211]
    v_mfma_f32_16x16x32_bf16 a[216:219], a[200:203], a[128:131], a[216:219]
    v_mfma_f32_16x16x32_bf16 a[204:207], a[52:55], a[52:55], a[204:207]
    v_mfma_f32_16x16x32_bf16 a[212:215], a[200:203], a[52:55], a[212:215]
    v_mfma_f32_16x16x32_bf16 a[208:211], a[132:135], a[132:135], a[208:211]
    v_mfma_f32_16x16x32_bf16 a[216:219], a[200:203], a[132:135], a[216:219]
    s_waitcnt vmcnt(13)
    ds_read_b128 a[64:67], v76 offset:1024
    ds_read_b128 a[68:71], v77 offset:1024
    ds_read_b128 a[144:147], v76 offset:3072
    ds_read_b128 a[148:151], v77 offset:3072
    s_waitcnt lgkmcnt(4)
    v_mfma_f32_16x16x32_bf16 a[204:207], a[56:59], a[56:59], a[204:207]
    v_mfma_f32_16x16x32_bf16 a[212:215], a[200:203], a[56:59], a[212:215]
    v_mfma_f32_16x16x32_bf16 a[208:211], a[136:139], a[136:139], a[208:211]
    v_mfma_f32_16x16x32_bf16 a[216:219], a[200:203], a[136:139], a[216:219]
    v_mfma_f32_16x16x32_bf16 a[204:207], a[60:63], a[60:63], a[204:207]
    v_mfma_f32_16x16x32_bf16 a[212:215], a[200:203], a[60:63], a[212:215]
    v_mfma_f32_16x16x32_bf16 a[208:211], a[140:143], a[140:143], a[208:211]
    v_mfma_f32_16x16x32_bf16 a[216:219], a[200:203], a[140:143], a[216:219]
    s_waitcnt vmcnt(9)
    ds_read_b128 a[72:75], v76 offset:21504
    ds_read_b128 a[76:79], v77 offset:21504
    ds_read_b128 a[152:155], v76 offset:23552
    ds_read_b128 a[156:159], v77 offset:23552
    s_waitcnt lgkmcnt(4)
    v_mfma_f32_16x16x32_bf16 a[204:207], a[64:67], a[64:67], a[204:207]
    v_mfma_f32_16x16x32_bf16 a[212:215], a[200:203], a[64:67], a[212:215]
    v_mfma_f32_16x16x32_bf16 a[208:211], a[144:147], a[144:147], a[208:211]
    v_mfma_f32_16x16x32_bf16 a[216:219], a[200:203], a[144:147], a[216:219]
    v_mfma_f32_16x16x32_bf16 a[204:207], a[68:71], a[68:71], a[204:207]
    v_mfma_f32_16x16x32_bf16 a[212:215], a[200:203], a[68:71], a[212:215]
    v_mfma_f32_16x16x32_bf16 a[208:211], a[148:151], a[148:151], a[208:211]
    v_mfma_f32_16x16x32_bf16 a[216:219], a[200:203], a[148:151], a[216:219]
    s_waitcnt lgkmcnt(0)
    s_mov_b32 s78, 0
L_h0p:
    buffer_load_dword v16, v26, s[40:43], s55 offen sc1
    s_waitcnt vmcnt(0)
    v_cmp_ne_u32 vcc, s76, v16
    s_cbranch_vccz L_h0ok
    s_add_u32 s78, s78, 1
    s_cmp_lt_u32 s78, 32768
    s_cbranch_scc1 L_h0p
L_h0ok:
    s_add_u32 m0, s52, 0
    s_add_u32 s57, s54, m0
    buffer_load_dwordx4 v8, s[40:43], s57 offen offset:0 sc1 lds
    buffer_load_dwordx4 v8, s[40:43], s57 offen offset:1024 sc1 lds
    buffer_load_dwordx4 v8, s[40:43], s57 offen offset:2048 sc1 lds
    buffer_load_dwordx4 v8, s[40:43], s57 offen offset:3072 sc1 lds
    s_add_u32 m0, s52, 4096
    s_nop 0
    buffer_load_dwordx4 v12, s[40:43], s57 offen offset:0 sc1 lds
    s_add_u32 m0, s52, 20480
    s_add_u32 s57, s54, m0
    buffer_load_dwordx4 v8, s[40:43], s57 offen offset:0 sc1 lds
    buffer_load_dwordx4 v8, s[40:43], s57 offen offset:1024 sc1 lds
    buffer_load_dwordx4 v8, s[40:43], s57 offen offset:2048 sc1 lds
    buffer_load_dwordx4 v8, s[40:43], s57 offen offset:3072 sc1 lds
    s_add_u32 m0, s52, 24576
    s_nop 0
    buffer_load_dwordx4 v12, s[40:43], s57 offen offset:0 sc1 lds
    s_waitcnt lgkmcnt(0)
    v_mfma_f32_16x16x32_bf16 a[204:207], a[72:75], a[72:75], a[204:207]
    v_mfma_f32_16x16x32_bf16 a[212:215], a[200:203], a[72:75], a[212:215]
    v_mfma_f32_16x16x32_bf16 a[208:211], a[152:155], a[152:155], a[208:211]
    v_mfma_f32_16x16x32_bf16 a[216:219], a[200:203], a[152:155], a[216:219]
    v_mfma_f32_16x16x32_bf16 a[204:207], a[76:79], a[76:79], a[204:207]
    v_mfma_f32_16x16x32_bf16 a[212:215], a[200:203], a[76:79], a[212:215]
    v_mfma_f32_16x16x32_bf16 a[208:211], a[156:159], a[156:159], a[208:211]
    v_mfma_f32_16x16x32_bf16 a[216:219], a[200:203], a[156:159], a[216:219]
    s_cmp_eq_u32 s72, 2
    s_cbranch_scc1 L_rp_f5
    v_bfe_u32 v28, v1, 2, 2
    v_lshl_add_u32 v27, v11, 3, v28
    v_and_b32 v28, 3, v1
    v_mul_u32_u24 v29, 224, v27
    v_add_u32 v29, s71, v29
    v_lshl_add_u32 v30, v28, 3, v29
    v_lshl_add_u32 v29, v28, 4, v29
    ds_read_b64_tr_b16 v[116:117], v29 offset:0
    ds_read_b64_tr_b16 v[118:119], v29 offset:896
    ds_read_b64_tr_b16 v[120:121], v29 offset:8
    ds_read_b64_tr_b16 v[122:123], v29 offset:904
    ds_read_b64_tr_b16 v[124:125], v29 offset:64
    ds_read_b64_tr_b16 v[126:127], v29 offset:960
    ds_read_b64_tr_b16 v[128:129], v29 offset:72
    ds_read_b64_tr_b16 v[130:131], v29 offset:968
    ds_read_b64_tr_b16 v[132:133], v29 offset:128
    ds_read_b64_tr_b16 v[134:135], v29 offset:1024
    ds_read_b64_tr_b16 v[136:137], v29 offset:136
    ds_read_b64_tr_b16 v[138:139], v29 offset:1032
    ds_read_b64_tr_b16 v[140:141], v30 offset:192
    ds_read_b64_tr_b16 v[142:143], v30 offset:1088
    v_mov_b32 v28, 0x3f803f80
    v_cmp_eq_u32 vcc, 20, v10
    s_nop 1
    v_cndmask_b32 v144, 0, v28, vcc
    v_cndmask_b32 v145, 0, v28, vcc
    v_cndmask_b32 v146, 0, v28, vcc
    v_cndmask_b32 v147, 0, v28, vcc
    v_cmp_eq_u32 vcc, 24, v10
    s_nop 1
    v_cndmask_b32 v148, 0, v28, vcc
    v_cndmask_b32 v149, 0, v28, vcc
    v_cndmask_b32 v150, 0, v28, vcc
    v_cndmask_b32 v151, 0, v28, vcc
    s_waitcnt lgkmcnt(0)
    v_mfma_f32_16x16x32_bf16 v[152:155], v[116:119], a[220:223], 0
    v_mfma_f32_16x16x32_bf16 v[152:155], v[120:123], a[224:227], v[152:155]
    v_mfma_f32_16x16x32_bf16 v[152:155], v[124:127], a[228:231], v[152:155]
    v_mfma_f32_16x16x32_bf16 v[152:155], v[128:131], a[232:235], v[152:155]
    v_mfma_f32_16x16x32_bf16 v[152:155], v[132:135], a[236:239], v[152:155]
    v_mfma_f32_16x16x32_bf16 v[152:155], v[136:139], v[144:147], v[152:155]
    v_mfma_f32_16x16x32_bf16 v[152:155], v[140:143], v[148:151], v[152:155]
    s_branch L_rp_done
L_rp_f5:
    v_bfe_u32 v28, v1, 2, 2
    v_lshl_add_u32 v27, v11, 3, v28
    v_and_b32 v28, 3, v1
    v_mul_u32_u24 v29, 160, v27
    v_add_u32 v29, s71, v29
    v_lshl_add_u32 v30, v28, 3, v29
    v_lshl_add_u32 v29, v28, 4, v29
    ds_read_b64_tr_b16 v[116:117], v29 offset:0
    ds_read_b64_tr_b16 v[118:119], v29 offset:640
    ds_read_b64_tr_b16 v[120:121], v29 offset:8
    ds_read_b64_tr_b16 v[122:123], v29 offset:648
    ds_read_b64_tr_b16 v[124:125], v29 offset:64
    ds_read_b64_tr_b16 v[126:127], v29 offset:704
    ds_read_b64_tr_b16 v[128:129], v29 offset:72
    ds_read_b64_tr_b16 v[130:131], v29 offset:712
    ds_read_b64_tr_b16 v[132:133], v30 offset:128
    ds_read_b64_tr_b16 v[134:135], v30 offset:768
    s_waitcnt lgkmcnt(0)
L_rp_done:
    v_accvgpr_read_b32 v160, a204
    v_accvgpr_read_b32 v161, a205
    v_accvgpr_read_b32 v162, a206
    v_accvgpr_read_b32 v163, a207
    v_accvgpr_read_b32 v164, a212
    v_cndmask_b32 v160, v160, v161, s[68:69]
    v_cndmask_b32 v162, v162, v163, s[68:69]
    v_mul_f32 v164, s63, v164
    v_cndmask_b32 v160, v160, v162, s[86:87]
    v_mul_f32 v160, s63, v160
    v_fma_f32 v160, -v164, v164, v160
    v_max_f32 v160, 0, v160
    v_add_f32 v160, s64, v160
    v_rsq_f32 v160, v160
    s_nop 0
    v_mul_f32 v164, v164, v160
    ds_write_b32 v25, v160 offset:0
    ds_write_b32 v25, v164 offset:128
    v_accvgpr_read_b32 v160, a208
    v_accvgpr_read_b32 v161, a209
    v_accvgpr_read_b32 v162, a210
    v_accvgpr_read_b32 v163, a211
    v_accvgpr_read_b32 v164, a216
    v_cndmask_b32 v160, v160, v161, s[68:69]
    v_cndmask_b32 v162, v162, v163, s[68:69]
    v_mul_f32 v164, s63, v164
    v_cndmask_b32 v160, v160, v162, s[86:87]
    v_mul_f32 v160, s63, v160
    v_fma_f32 v160, -v164, v164, v160
    v_max_f32 v160, 0, v160
    v_add_f32 v160, s64, v160
    v_rsq_f32 v160, v160
    s_nop 0
    v_mul_f32 v164, v164, v160
    ds_write_b32 v25, v160 offset:64
    ds_write_b32 v25, v164 offset:192
    v_lshlrev_b32 v28, 4, v11
    v_add_u32 v28, s48, v28
    v_add_u32 v29, s48, v10
    ds_read_b128 v[96:99], v28 offset:0
    ds_read_b128 v[104:107], v28 offset:128
    ds_read_b32 v112, v29 offset:0
    ds_read_b32 v114, v29 offset:128
    ds_read_b128 v[100:103], v28 offset:64
    ds_read_b128 v[108:111], v28 offset:192
    ds_read_b32 v113, v29 offset:64
    ds_read_b32 v115, v29 offset:192
    s_add_u32 m0, s52, 40960
    s_add_u32 s57, s54, m0
    buffer_load_dwordx4 v8, s[40:43], s57 offen offset:0 sc1 lds
    buffer_load_dwordx4 v8, s[40:43], s57 offen offset:1024 sc1 lds
    buffer_load_dwordx4 v8, s[40:43], s57 offen offset:2048 sc1 lds
    buffer_load_dwordx4 v8, s[40:43], s57 offen offset:3072 sc1 lds
    s_add_u32 m0, s52, 45056
    s_nop 0
    buffer_load_dwordx4 v12, s[40:43], s57 offen offset:0 sc1 lds
    s_lshl_b32 s73, s70, 9
    s_add_u32 s73, s73, 5324800
    s_cmp_eq_u32 s72, 2
    s_cselect_b32 s75, 0x40000000, s74
    s_cselect_b32 s73, 0x40000000, s73
    v_lshlrev_b32 v85, 4, v11
    v_lshl_add_u32 v85, v10, 4, v85
    v_cndmask_b32 v85, v2, v85, s[66:67]
    s_and_b32 s59, s27, 7
    s_lshl_b32 s59, s59, 9
    s_add_u32 s59, s59, 21477376
    s_lshr_b32 s3, s27, 3
    s_lshl_b32 s3, s3, 4
    s_add_u32 s3, s3, s26
    s_lshl_b32 s3, s3, 2
    s_add_u32 s3, s3, s28
    s_lshl_b32 s3, s3, 2
    s_add_u32 s70, s3, s59
    s_waitcnt vmcnt(10)
    s_barrier
    s_mov_b32 s94, s60
    s_mov_b32 s95, s60
    s_mov_b32 s96, s61
    s_mov_b32 s97, s61
    ds_read_b128 a[160:163], v17 offset:0
    ds_read_b128 a[164:167], v17 offset:1024
    ds_read_b128 a[168:171], v17 offset:2048
    ds_read_b128 a[172:175], v17 offset:3072
    ds_read_b128 a[176:179], v17 offset:4096
    s_and_b32 s3, s27, 7
    s_mul_i32 s3, s3, 20
    s_add_u32 s3, s3, s28
    s_mul_i32 s65, s3, 5120
    s_add_u32 s65, s65, 0
    s_waitcnt lgkmcnt(0)
    v_mfma_f32_16x16x32_bf16 v[32:35], a[0:3], a[160:163], 0
    ds_read_b128 a[180:183], v18 offset:0
    s_add_u32 m0, s52, 61440
    s_add_u32 s57, s54, m0
    buffer_load_dwordx4 v8, s[40:43], s57 offen offset:0 sc1 lds
    v_mfma_f32_16x16x32_bf16 v[52:55], a[80:83], a[160:163], 0
    ds_read_b128 a[184:187], v18 offset:1024
    v_mfma_f32_16x16x32_bf16 a[240:243], a[220:223], a[160:163], 0
    ds_read_b128 a[188:191], v18 offset:2048
    v_mfma_f32_16x16x32_bf16 v[36:39], a[0:3], a[164:167], 0
    ds_read_b128 a[192:195], v18 offset:3072
    v_mfma_f32_16x16x32_bf16 v[56:59], a[80:83], a[164:167], 0
    ds_read_b128 a[196:199], v18 offset:4096
    v_mfma_f32_16x16x32_bf16 a[240:243], a[224:227], a[164:167], a[240:243]
    buffer_load_dwordx4 v8, s[40:43], s57 offen offset:1024 sc1 lds
    v_mfma_f32_16x16x32_bf16 v[40:43], a[0:3], a[168:171], 0
    v_mfma_f32_16x16x32_bf16 v[60:63], a[80:83], a[168:171], 0
    v_mfma_f32_16x16x32_bf16 a[240:243], a[228:231], a[168:171], a[240:243]
    v_mfma_f32_16x16x32_bf16 v[44:47], a[0:3], a[172:175], 0
    v_mfma_f32_16x16x32_bf16 v[64:67], a[80:83], a[172:175], 0
    buffer_load_dwordx4 v8, s[40:43], s57 offen offset:2048 sc1 lds
    v_mfma_f32_16x16x32_bf16 a[240:243], a[232:235], a[172:175], a[240:243]
    v_mfma_f32_16x16x32_bf16 v[48:51], a[0:3], a[176:179], 0
    v_mfma_f32_16x16x32_bf16 v[68:71], a[80:83], a[176:179], 0
    v_mfma_f32_16x16x32_bf16 a[240:243], a[236:239], a[176:179], a[240:243]
    s_waitcnt lgkmcnt(0)
    v_mfma_f32_16x16x32_bf16 v[32:35], a[4:7], a[180:183], v[32:35]
    ds_read_b128 a[160:163], v19 offset:0
    buffer_load_dwordx4 v8, s[40:43], s57 offen offset:3072 sc1 lds
    v_mfma_f32_16x16x32_bf16 v[52:55], a[84:87], a[180:183], v[52:55]
    ds_read_b128 a[164:167], v19 offset:1024
    v_mfma_f32_16x16x32_bf16 v[36:39], a[4:7], a[184:187], v[36:39]
    ds_read_b128 a[168:171], v19 offset:2048
    v_mfma_f32_16x16x32_bf16 v[56:59], a[84:87], a[184:187], v[56:59]
    ds_read_b128 a[172:175], v19 offset:3072
    s_add_u32 m0, s52, 65536
    s_nop 0
    buffer_load_dwordx4 v12, s[40:43], s57 offen offset:0 sc1 lds
    v_mfma_f32_16x16x32_bf16 v[40:43], a[4:7], a[188:191], v[40:43]
    ds_read_b128 a[176:179], v19 offset:4096
    v_mfma_f32_16x16x32_bf16 v[60:63], a[84:87], a[188:191], v[60:63]
    v_mfma_f32_16x16x32_bf16 v[44:47], a[4:7], a[192:195], v[44:47]
    s_add_u32 m0, s52, 81920
    s_add_u32 s57, s54, m0
    buffer_load_dwordx4 v8, s[40:43], s57 offen offset:0 sc1 lds
    v_mfma_f32_16x16x32_bf16 v[64:67], a[84:87], a[192:195], v[64:67]
    v_mfma_f32_16x16x32_bf16 v[48:51], a[4:7], a[196:199], v[48:51]
    v_mfma_f32_16x16x32_bf16 v[68:71], a[84:87], a[196:199], v[68:71]
    s_waitcnt lgkmcnt(0)
    v_mfma_f32_16x16x32_bf16 v[32:35], a[8:11], a[160:163], v[32:35]
    ds_read_b128 a[180:183], v20 offset:0
    buffer_load_dwordx4 v8, s[40:43], s57 offen offset:1024 sc1 lds
    v_mfma_f32_16x16x32_bf16 v[52:55], a[88:91], a[160:163], v[52:55]
    ds_read_b128 a[184:187], v20 offset:1024
    v_mfma_f32_16x16x32_bf16 v[36:39], a[8:11], a[164:167], v[36:39]
    ds_read_b128 a[188:191], v20 offset:2048
    v_mfma_f32_16x16x32_bf16 v[56:59], a[88:91], a[164:167], v[56:59]
    ds_read_b128 a[192:195], v20 offset:3072
    buffer_load_dwordx4 v8, s[40:43], s57 offen offset:2048 sc1 lds
    v_mfma_f32_16x16x32_bf16 v[40:43], a[8:11], a[168:171], v[40:43]
    ds_read_b128 a[196:199], v20 offset:4096
    v_mfma_f32_16x16x32_bf16 v[60:63], a[88:91], a[168:171], v[60:63]
    v_mfma_f32_16x16x32_bf16 v[44:47], a[8:11], a[172:175], v[44:47]
    buffer_load_dwordx4 v8, s[40:43], s57 offen offset:3072 sc1 lds
    v_mfma_f32_16x16x32_bf16 v[64:67], a[88:91], a[172:175], v[64:67]
    v_mfma_f32_16x16x32_bf16 v[48:51], a[8:11], a[176:179], v[48:51]
    v_mfma_f32_16x16x32_bf16 v[68:71], a[88:91], a[176:179], v[68:71]
    s_waitcnt vmcnt(14)
    s_barrier
    s_waitcnt lgkmcnt(0)
    v_mfma_f32_16x16x32_bf16 v[32:35], a[12:15], a[180:183], v[32:35]
    ds_read_b128 a[160:163], v17 offset:20480
    s_add_u32 m0, s52, 86016
    s_nop 0
    buffer_load_dwordx4 v12, s[40:43], s57 offen offset:0 sc1 lds
    v_mfma_f32_16x16x32_bf16 v[52:55], a[92:95], a[180:183], v[52:55]
    ds_read_b128 a[164:167], v17 offset:21504
    v_mfma_f32_16x16x32_bf16 v[36:39], a[12:15], a[184:187], v[36:39]
    ds_read_b128 a[168:171], v17 offset:22528
    v_mfma_f32_16x16x32_bf16 v[56:59], a[92:95], a[184:187], v[56:59]
    ds_read_b128 a[172:175], v17 offset:23552
    v_mfma_f32_16x16x32_bf16 v[40:43], a[12:15], a[188:191], v[40:43]
    ds_read_b128 a[176:179], v17 offset:24576
    v_mfma_f32_16x16x32_bf16 v[60:63], a[92:95], a[188:191], v[60:63]
    v_mfma_f32_16x16x32_bf16 v[44:47], a[12:15], a[192:195], v[44:47]
    v_mfma_f32_16x16x32_bf16 v[64:67], a[92:95], a[192:195], v[64:67]
    v_mfma_f32_16x16x32_bf16 v[48:51], a[12:15], a[196:199], v[48:51]
    v_mfma_f32_16x16x32_bf16 v[68:71], a[92:95], a[196:199], v[68:71]
    s_waitcnt lgkmcnt(0)
    v_mfma_f32_16x16x32_bf16 v[32:35], a[16:19], a[160:163], v[32:35]
    ds_read_b128 a[180:183], v18 offset:20480
    v_mfma_f32_16x16x32_bf16 v[52:55], a[96:99], a[160:163], v[52:55]
    ds_read_b128 a[184:187], v18 offset:21504
    v_mfma_f32_16x16x32_bf16 a[240:243], a[220:223], a[160:163], a[240:243]
    ds_read_b128 a[188:191], v18 offset:22528
    v_mfma_f32_16x16x32_bf16 v[36:39], a[16:19], a[164:167], v[36:39]
    ds_read_b128 a[192:195], v18 offset:23552
    v_mfma_f32_16x16x32_bf16 v[56:59], a[96:99], a[164:167], v[56:59]
    ds_read_b128 a[196:199], v18 offset:24576
    v_mfma_f32_16x16x32_bf16 a[240:243], a[224:227], a[164:167], a[240:243]
    v_mfma_f32_16x16x32_bf16 v[40:43], a[16:19], a[168:171], v[40:43]
    v_mfma_f32_16x16x32_bf16 v[60:63], a[96:99], a[168:171], v[60:63]
    v_mfma_f32_16x16x32_bf16 a[240:243], a[228:231], a[168:171], a[240:243]
    v_mfma_f32_16x16x32_bf16 v[44:47], a[16:19], a[172:175], v[44:47]
    v_mfma_f32_16x16x32_bf16 v[64:67], a[96:99], a[172:175], v[64:67]
    v_mfma_f32_16x16x32_bf16 a[240:243], a[232:235], a[172:175], a[240:243]
    v_mfma_f32_16x16x32_bf16 v[48:51], a[16:19], a[176:179], v[48:51]
    v_mfma_f32_16x16x32_bf16 v[68:71], a[96:99], a[176:179], v[68:71]
    v_mfma_f32_16x16x32_bf16 a[240:243], a[236:239], a[176:179], a[240:243]
    s_waitcnt lgkmcnt(0)
    v_mfma_f32_16x16x32_bf16 v[32:35], a[20:23], a[180:183], v[32:35]
    ds_read_b128 a[160:163], v19 offset:20480
    v_mfma_f32_16x16x32_bf16 v[52:55], a[100:103], a[180:183], v[52:55]
    ds_read_b128 a[164:167], v19 offset:21504
    v_mfma_f32_16x16x32_bf16 v[36:39], a[20:23], a[184:187], v[36:39]
    ds_read_b128 a[168:171], v19 offset:22528
    v_mfma_f32_16x16x32_bf16 v[56:59], a[100:103], a[184:187], v[56:59]
    ds_read_b128 a[172:175], v19 offset:23552
    v_mfma_f32_16x16x32_bf16 v[40:43], a[20:23], a[188:191], v[40:43]
    ds_read_b128 a[176:179], v19 offset:24576
    v_mfma_f32_16x16x32_bf16 v[60:63], a[100:103], a[188:191], v[60:63]
    v_mfma_f32_16x16x32_bf16 v[44:47], a[20:23], a[192:195], v[44:47]
    v_mfma_f32_16x16x32_bf16 v[64:67], a[100:103], a[192:195], v[64:67]
    v_mfma_f32_16x16x32_bf16 v[48:51], a[20:23], a[196:199], v[48:51]
    v_mfma_f32_16x16x32_bf16 v[68:71], a[100:103], a[196:199], v[68:71]
    s_waitcnt lgkmcnt(0)
    v_mfma_f32_16x16x32_bf16 v[32:35], a[24:27], a[160:163], v[32:35]
    ds_read_b128 a[180:183], v20 offset:20480
    buffer_store_dwordx4 v[116:119], v8, s[40:43], s74 offen offset:0 sc1
    v_mfma_f32_16x16x32_bf16 v[52:55], a[104:107], a[160:163], v[52:55]
    ds_read_b128 a[184:187], v20 offset:21504
    v_mfma_f32_16x16x32_bf16 v[36:39], a[24:27], a[164:167], v[36:39]
    ds_read_b128 a[188:191], v20 offset:22528
    v_mfma_f32_16x16x32_bf16 v[56:59], a[104:107], a[164:167], v[56:59]
    ds_read_b128 a[192:195], v20 offset:23552
    v_mfma_f32_16x16x32_bf16 v[40:43], a[24:27], a[168:171], v[40:43]
    ds_read_b128 a[196:199], v20 offset:24576
    v_mfma_f32_16x16x32_bf16 v[60:63], a[104:107], a[168:171], v[60:63]
    v_mfma_f32_16x16x32_bf16 v[44:47], a[24:27], a[172:175], v[44:47]
    v_mfma_f32_16x16x32_bf16 v[64:67], a[104:107], a[172:175], v[64:67]
    v_mfma_f32_16x16x32_bf16 v[48:51], a[24:27], a[176:179], v[48:51]
    v_mfma_f32_16x16x32_bf16 v[68:71], a[104:107], a[176:179], v[68:71]
    s_waitcnt vmcnt(11)
    s_barrier
    s_waitcnt lgkmcnt(0)
    v_mfma_f32_16x16x32_bf16 v[32:35], a[28:31], a[180:183], v[32:35]
    ds_read_b128 a[160:163], v17 offset:40960
    buffer_store_dwordx4 v[120:123], v8, s[40:43], s74 offen offset:1024 sc1
    v_mfma_f32_16x16x32_bf16 v[52:55], a[108:111], a[180:183], v[52:55]
    ds_read_b128 a[164:167], v17 offset:41984
    v_mfma_f32_16x16x32_bf16 v[36:39], a[28:31], a[184:187], v[36:39]
    ds_read_b128 a[168:171], v17 offset:43008
    v_mfma_f32_16x16x32_bf16 v[56:59], a[108:111], a[184:187], v[56:59]
    ds_read_b128 a[172:175], v17 offset:44032
    v_mfma_f32_16x16x32_bf16 v[40:43], a[28:31], a[188:191], v[40:43]
    ds_read_b128 a[176:179], v17 offset:45056
    v_mfma_f32_16x16x32_bf16 v[60:63], a[108:111], a[188:191], v[60:63]
    v_add_u32 v17, 61440, v17
    v_mfma_f32_16x16x32_bf16 v[44:47], a[28:31], a[192:195], v[44:47]
    v_mfma_f32_16x16x32_bf16 v[64:67], a[108:111], a[192:195], v[64:67]
    v_mfma_f32_16x16x32_bf16 v[48:51], a[28:31], a[196:199], v[48:51]
    v_mfma_f32_16x16x32_bf16 v[68:71], a[108:111], a[196:199], v[68:71]
    s_waitcnt lgkmcnt(0)
    v_mfma_f32_16x16x32_bf16 v[32:35], a[32:35], a[160:163], v[32:35]
    ds_read_b128 a[180:183], v18 offset:40960
    buffer_store_dwordx4 v[124:127], v8, s[40:43], s74 offen offset:2048 sc1
    v_mfma_f32_16x16x32_bf16 v[52:55], a[112:115], a[160:163], v[52:55]
    ds_read_b128 a[184:187], v18 offset:41984
    v_mfma_f32_16x16x32_bf16 a[240:243], a[220:223], a[160:163], a[240:243]
    ds_read_b128 a[188:191], v18 offset:43008
    v_mfma_f32_16x16x32_bf16 v[36:39], a[32:35], a[164:167], v[36:39]
    ds_read_b128 a[192:195], v18 offset:44032
    v_mfma_f32_16x16x32_bf16 v[56:59], a[112:115], a[164:167], v[56:59]
    ds_read_b128 a[196:199], v18 offset:45056
    v_mfma_f32_16x16x32_bf16 a[240:243], a[224:227], a[164:167], a[240:243]
    v_add_u32 v18, 61440, v18
    v_mfma_f32_16x16x32_bf16 v[40:43], a[32:35], a[168:171], v[40:43]
    v_mfma_f32_16x16x32_bf16 v[60:63], a[112:115], a[168:171], v[60:63]
    v_mfma_f32_16x16x32_bf16 a[240:243], a[228:231], a[168:171], a[240:243]
    v_mfma_f32_16x16x32_bf16 v[44:47], a[32:35], a[172:175], v[44:47]
    v_mfma_f32_16x16x32_bf16 v[64:67], a[112:115], a[172:175], v[64:67]
    v_mfma_f32_16x16x32_bf16 a[240:243], a[232:235], a[172:175], a[240:243]
    v_mfma_f32_16x16x32_bf16 v[48:51], a[32:35], a[176:179], v[48:51]
    v_mfma_f32_16x16x32_bf16 v[68:71], a[112:115], a[176:179], v[68:71]
    v_mfma_f32_16x16x32_bf16 a[240:243], a[236:239], a[176:179], a[240:243]
    s_waitcnt lgkmcnt(0)
    v_mfma_f32_16x16x32_bf16 v[32:35], a[36:39], a[180:183], v[32:35]
    ds_read_b128 a[160:163], v19 offset:40960
    buffer_store_dwordx4 v[128:131], v8, s[40:43], s74 offen offset:3072 sc1
    v_mfma_f32_16x16x32_bf16 v[52:55], a[116:119], a[180:183], v[52:55]
    ds_read_b128 a[164:167], v19 offset:41984
    v_mfma_f32_16x16x32_bf16 v[36:39], a[36:39], a[184:187], v[36:39]
    ds_read_b128 a[168:171], v19 offset:43008
    v_mfma_f32_16x16x32_bf16 v[56:59], a[116:119], a[184:187], v[56:59]
    ds_read_b128 a[172:175], v19 offset:44032
    v_mfma_f32_16x16x32_bf16 v[40:43], a[36:39], a[188:191], v[40:43]
    ds_read_b128 a[176:179], v19 offset:45056
    v_mfma_f32_16x16x32_bf16 v[60:63], a[116:119], a[188:191], v[60:63]
    v_add_u32 v19, 61440, v19
    v_mfma_f32_16x16x32_bf16 v[44:47], a[36:39], a[192:195], v[44:47]
    v_mfma_f32_16x16x32_bf16 v[64:67], a[116:119], a[192:195], v[64:67]
    v_mfma_f32_16x16x32_bf16 v[48:51], a[36:39], a[196:199], v[48:51]
    v_mfma_f32_16x16x32_bf16 v[68:71], a[116:119], a[196:199], v[68:71]
    s_waitcnt lgkmcnt(0)
    v_mfma_f32_16x16x32_bf16 v[32:35], a[40:43], a[160:163], v[32:35]
    ds_read_b128 a[180:183], v20 offset:40960
    buffer_store_dwordx4 v[132:135], v12, s[40:43], s74 offen offset:0 sc1
    v_mfma_f32_16x16x32_bf16 v[52:55], a[120:123], a[160:163], v[52:55]
    ds_read_b128 a[184:187], v20 offset:41984
    v_mfma_f32_16x16x32_bf16 v[36:39], a[40:43], a[164:167], v[36:39]
    ds_read_b128 a[188:191], v20 offset:43008
    v_mfma_f32_16x16x32_bf16 v[56:59], a[120:123], a[164:167], v[56:59]
    ds_read_b128 a[192:195], v20 offset:44032
    v_mfma_f32_16x16x32_bf16 v[40:43], a[40:43], a[168:171], v[40:43]
    ds_read_b128 a[196:199], v20 offset:45056
    v_mfma_f32_16x16x32_bf16 v[60:63], a[120:123], a[168:171], v[60:63]
    v_add_u32 v20, 61440, v20
    v_mfma_f32_16x16x32_bf16 v[44:47], a[40:43], a[172:175], v[44:47]
    v_mfma_f32_16x16x32_bf16 v[64:67], a[120:123], a[172:175], v[64:67]
    v_mfma_f32_16x16x32_bf16 v[48:51], a[40:43], a[176:179], v[48:51]
    v_mfma_f32_16x16x32_bf16 v[68:71], a[120:123], a[176:179], v[68:71]
    s_waitcnt vmcnt(10)
    s_barrier
    s_waitcnt lgkmcnt(0)
    v_mfma_f32_16x16x32_bf16 v[32:35], a[44:47], a[180:183], v[32:35]
    ds_read_b128 a[160:163], v17 offset:0
    buffer_store_dwordx4 v[136:139], v12, s[40:43], s75 offen offset:1024 sc1
    v_mfma_f32_16x16x32_bf16 v[52:55], a[124:127], a[180:183], v[52:55]
    ds_read_b128 a[164:167], v17 offset:1024
    v_mfma_f32_16x16x32_bf16 v[36:39], a[44:47], a[184:187], v[36:39]
    ds_read_b128 a[168:171], v17 offset:2048
    v_mfma_f32_16x16x32_bf16 v[56:59], a[124:127], a[184:187], v[56:59]
    ds_read_b128 a[172:175], v17 offset:3072
    v_mfma_f32_16x16x32_bf16 v[40:43], a[44:47], a[188:191], v[40:43]
    ds_read_b128 a[176:179], v17 offset:4096
    v_mfma_f32_16x16x32_bf16 v[60:63], a[124:127], a[188:191], v[60:63]
    v_mfma_f32_16x16x32_bf16 v[44:47], a[44:47], a[192:195], v[44:47]
    v_mfma_f32_16x16x32_bf16 v[64:67], a[124:127], a[192:195], v[64:67]
    v_mfma_f32_16x16x32_bf16 v[48:51], a[44:47], a[196:199], v[48:51]
    v_mfma_f32_16x16x32_bf16 v[68:71], a[124:127], a[196:199], v[68:71]
    s_waitcnt lgkmcnt(0)
    v_mfma_f32_16x16x32_bf16 v[32:35], a[48:51], a[160:163], v[32:35]
    ds_read_b128 a[180:183], v18 offset:0
    buffer_store_dwordx4 v[140:143], v12, s[40:43], s75 offen offset:2048 sc1
    v_mfma_f32_16x16x32_bf16 v[52:55], a[128:131], a[160:163], v[52:55]
    ds_read_b128 a[184:187], v18 offset:1024
    v_mfma_f32_16x16x32_bf16 a[240:243], a[220:223], a[160:163], a[240:243]
    ds_read_b128 a[188:191], v18 offset:2048
    v_mfma_f32_16x16x32_bf16 v[36:39], a[48:51], a[164:167], v[36:39]
    ds_read_b128 a[192:195], v18 offset:3072
    v_mfma_f32_16x16x32_bf16 v[56:59], a[128:131], a[164:167], v[56:59]
    ds_read_b128 a[196:199], v18 offset:4096
    v_mfma_f32_16x16x32_bf16 a[240:243], a[224:227], a[164:167], a[240:243]
    v_mfma_f32_16x16x32_bf16 v[40:43], a[48:51], a[168:171], v[40:43]
    v_mfma_f32_16x16x32_bf16 v[60:63], a[128:131], a[168:171], v[60:63]
    v_mfma_f32_16x16x32_bf16 a[240:243], a[228:231], a[168:171], a[240:243]
    v_mfma_f32_16x16x32_bf16 v[44:47], a[48:51], a[172:175], v[44:47]
    v_mfma_f32_16x16x32_bf16 v[64:67], a[128:131], a[172:175], v[64:67]
    v_mfma_f32_16x16x32_bf16 a[240:243], a[232:235], a[172:175], a[240:243]
    v_mfma_f32_16x16x32_bf16 v[48:51], a[48:51], a[176:179], v[48:51]
    v_mfma_f32_16x16x32_bf16 v[68:71], a[128:131], a[176:179], v[68:71]
    v_mfma_f32_16x16x32_bf16 a[240:243], a[236:239], a[176:179], a[240:243]
    s_waitcnt lgkmcnt(0)
    v_mfma_f32_16x16x32_bf16 v[32:35], a[52:55], a[180:183], v[32:35]
    ds_read_b128 a[160:163], v19 offset:0
    buffer_store_dwordx4 v[152:155], v85, s[40:43], s73 offen sc1
    v_mfma_f32_16x16x32_bf16 v[52:55], a[132:135], a[180:183], v[52:55]
    ds_read_b128 a[164:167], v19 offset:1024
    v_mfma_f32_16x16x32_bf16 v[36:39], a[52:55], a[184:187], v[36:39]
    ds_read_b128 a[168:171], v19 offset:2048
    v_mfma_f32_16x16x32_bf16 v[56:59], a[132:135], a[184:187], v[56:59]
    ds_read_b128 a[172:175], v19 offset:3072
    v_mfma_f32_16x16x32_bf16 v[40:43], a[52:55], a[188:191], v[40:43]
    ds_read_b128 a[176:179], v19 offset:4096
    v_mfma_f32_16x16x32_bf16 v[60:63], a[132:135], a[188:191], v[60:63]
    v_mfma_f32_16x16x32_bf16 v[44:47], a[52:55], a[192:195], v[44:47]
    v_mfma_f32_16x16x32_bf16 v[64:67], a[132:135], a[192:195], v[64:67]
    v_mfma_f32_16x16x32_bf16 v[48:51], a[52:55], a[196:199], v[48:51]
    v_mfma_f32_16x16x32_bf16 v[68:71], a[132:135], a[196:199], v[68:71]
    s_waitcnt lgkmcnt(0)
    v_mfma_f32_16x16x32_bf16 v[32:35], a[56:59], a[160:163], v[32:35]
    ds_read_b128 a[180:183], v20 offset:0
    s_mul_i32 s98, s28, 13312
    s_add_u32 m0, s98, 102400
    s_add_u32 s98, s54, m0
    buffer_load_dwordx4 v8, s[40:43], s98 offen sc1 lds
    v_mfma_f32_16x16x32_bf16 v[52:55], a[136:139], a[160:163], v[52:55]
    ds_read_b128 a[184:187], v20 offset:1024
    v_mfma_f32_16x16x32_bf16 v[36:39], a[56:59], a[164:167], v[36:39]
    ds_read_b128 a[188:191], v20 offset:2048
    v_mfma_f32_16x16x32_bf16 v[56:59], a[136:139], a[164:167], v[56:59]
    ds_read_b128 a[192:195], v20 offset:3072
    v_mfma_f32_16x16x32_bf16 v[40:43], a[56:59], a[168:171], v[40:43]
    ds_read_b128 a[196:199], v20 offset:4096
    v_mfma_f32_16x16x32_bf16 v[60:63], a[136:139], a[168:171], v[60:63]
    v_mfma_f32_16x16x32_bf16 v[44:47], a[56:59], a[172:175], v[44:47]
    v_mfma_f32_16x16x32_bf16 v[64:67], a[136:139], a[172:175], v[64:67]
    v_mfma_f32_16x16x32_bf16 v[48:51], a[56:59], a[176:179], v[48:51]
    v_mfma_f32_16x16x32_bf16 v[68:71], a[136:139], a[176:179], v[68:71]
    s_waitcnt vmcnt(9)
    s_barrier
    s_waitcnt lgkmcnt(0)
    v_mfma_f32_16x16x32_bf16 v[32:35], a[60:63], a[180:183], v[32:35]
    ds_read_b128 a[160:163], v17 offset:20480
    s_mul_i32 s98, s28, 13312
    s_add_u32 m0, s98, 103424
    s_add_u32 s98, s54, m0
    buffer_load_dwordx4 v8, s[40:43], s98 offen sc1 lds
    v_mfma_f32_16x16x32_bf16 v[52:55], a[140:143], a[180:183], v[52:55]
    ds_read_b128 a[164:167], v17 offset:21504
    v_mfma_f32_16x16x32_bf16 v[36:39], a[60:63], a[184:187], v[36:39]
    ds_read_b128 a[168:171], v17 offset:22528
    v_mfma_f32_16x16x32_bf16 v[56:59], a[140:143], a[184:187], v[56:59]
    ds_read_b128 a[172:175], v17 offset:23552
    v_mfma_f32_16x16x32_bf16 v[40:43], a[60:63], a[188:191], v[40:43]
    ds_read_b128 a[176:179], v17 offset:24576
    v_mfma_f32_16x16x32_bf16 v[60:63], a[140:143], a[188:191], v[60:63]
    v_mfma_f32_16x16x32_bf16 v[44:47], a[60:63], a[192:195], v[44:47]
    v_mfma_f32_16x16x32_bf16 v[64:67], a[140:143], a[192:195], v[64:67]
    v_mfma_f32_16x16x32_bf16 v[48:51], a[60:63], a[196:199], v[48:51]
    v_mfma_f32_16x16x32_bf16 v[68:71], a[140:143], a[196:199], v[68:71]
    s_waitcnt lgkmcnt(0)
    v_mfma_f32_16x16x32_bf16 v[32:35], a[64:67], a[160:163], v[32:35]
    ds_read_b128 a[180:183], v18 offset:20480
    s_mul_i32 s98, s28, 13312
    s_add_u32 m0, s98, 104448
    s_add_u32 s98, s54, m0
    buffer_load_dwordx4 v8, s[40:43], s98 offen sc1 lds
    v_mfma_f32_16x16x32_bf16 v[52:55], a[144:147], a[160:163], v[52:55]
    ds_read_b128 a[184:187], v18 offset:21504
    v_mfma_f32_16x16x32_bf16 a[240:243], a[220:223], a[160:163], a[240:243]
    ds_read_b128 a[188:191], v18 offset:22528
    v_mfma_f32_16x16x32_bf16 v[36:39], a[64:67], a[164:167], v[36:39]
    ds_read_b128 a[192:195], v18 offset:23552
    v_mfma_f32_16x16x32_bf16 v[56:59], a[144:147], a[164:167], v[56:59]
    ds_read_b128 a[196:199], v18 offset:24576
    v_mfma_f32_16x16x32_bf16 a[240:243], a[224:227], a[164:167], a[240:243]
    v_mfma_f32_16x16x32_bf16 v[40:43], a[64:67], a[168:171], v[40:43]
    v_mfma_f32_16x16x32_bf16 v[60:63], a[144:147], a[168:171], v[60:63]
    v_mfma_f32_16x16x32_bf16 a[240:243], a[228:231], a[168:171], a[240:243]
    v_mfma_f32_16x16x32_bf16 v[44:47], a[64:67], a[172:175], v[44:47]
    v_mfma_f32_16x16x32_bf16 v[64:67], a[144:147], a[172:175], v[64:67]
    v_mfma_f32_16x16x32_bf16 a[240:243], a[232:235], a[172:175], a[240:243]
    v_mfma_f32_16x16x32_bf16 v[48:51], a[64:67], a[176:179], v[48:51]
    v_mfma_f32_16x16x32_bf16 v[68:71], a[144:147], a[176:179], v[68:71]
    v_mfma_f32_16x16x32_bf16 a[240:243], a[236:239], a[176:179], a[240:243]
    s_waitcnt lgkmcnt(0)
    v_mfma_f32_16x16x32_bf16 v[32:35], a[68:71], a[180:183], v[32:35]
    ds_read_b128 a[160:163], v19 offset:20480
    s_mul_i32 s98, s28, 13312
    s_add_u32 m0, s98, 105472
    s_add_u32 s98, s54, m0
    buffer_load_dwordx4 v8, s[40:43], s98 offen sc1 lds
    v_mfma_f32_16x16x32_bf16 v[52:55], a[148:151], a[180:183], v[52:55]
    ds_read_b128 a[164:167], v19 offset:21504
    v_mfma_f32_16x16x32_bf16 v[36:39], a[68:71], a[184:187], v[36:39]
    ds_read_b128 a[168:171], v19 offset:22528
    s_lshl_b32 s3, s28, 9
    v_mfma_f32_16x16x32_bf16 v[56:59], a[148:151], a[184:187], v[56:59]
    ds_read_b128 a[172:175], v19 offset:23552
    v_mfma_f32_16x16x32_bf16 v[40:43], a[68:71], a[188:191], v[40:43]
    ds_read_b128 a[176:179], v19 offset:24576
    s_add_u32 s3, s3, 161792
    v_mfma_f32_16x16x32_bf16 v[60:63], a[148:151], a[188:191], v[60:63]
    v_mfma_f32_16x16x32_bf16 v[44:47], a[68:71], a[192:195], v[44:47]
    v_add_u32 v27, s3, v8
    v_mfma_f32_16x16x32_bf16 v[64:67], a[148:151], a[192:195], v[64:67]
    v_mfma_f32_16x16x32_bf16 v[48:51], a[68:71], a[196:199], v[48:51]
    s_bfm_b64 exec, 32, 0
    ds_write_b128 v27, a[240:243]
    s_mov_b64 exec, -1
    v_mfma_f32_16x16x32_bf16 v[68:71], a[148:151], a[196:199], v[68:71]
    s_waitcnt vmcnt(4)
    s_mov_b64 exec, 1
    buffer_store_dword v6, v5, s[40:43], s70 offen sc1
    s_mov_b64 exec, -1
    s_waitcnt lgkmcnt(0)
    s_barrier
    s_waitcnt lgkmcnt(1)
    v_mfma_f32_16x16x32_bf16 v[32:35], a[72:75], a[160:163], v[32:35]
    ds_read_b128 a[180:183], v20 offset:20480
    s_mul_i32 s98, s28, 13312
    s_add_u32 m0, s98, 106496
    s_add_u32 s98, s54, m0
    buffer_load_dwordx4 v8, s[40:43], s98 offen sc1 lds
    v_lshlrev_b32 v27, 2, v10
    v_mfma_f32_16x16x32_bf16 v[52:55], a[152:155], a[160:163], v[52:55]
    ds_read_b128 a[184:187], v20 offset:21504
    v_add_u32 v27, 161792, v27
    v_mfma_f32_16x16x32_bf16 v[36:39], a[72:75], a[164:167], v[36:39]
    ds_read_b128 a[188:191], v20 offset:22528
    ds_read_b128 v[116:119], v27 offset:0
    v_mfma_f32_16x16x32_bf16 v[56:59], a[152:155], a[164:167], v[56:59]
    ds_read_b128 a[192:195], v20 offset:23552
    ds_read_b32 v132, v27 offset:256
    v_mfma_f32_16x16x32_bf16 v[40:43], a[72:75], a[168:171], v[40:43]
    ds_read_b128 a[196:199], v20 offset:24576
    ds_read_b128 v[120:123], v27 offset:512
    v_mfma_f32_16x16x32_bf16 v[60:63], a[152:155], a[168:171], v[60:63]
    ds_read_b32 v133, v27 offset:768
    v_mfma_f32_16x16x32_bf16 v[44:47], a[72:75], a[172:175], v[44:47]
    ds_read_b128 v[124:127], v27 offset:1024
    v_mfma_f32_16x16x32_bf16 v[64:67], a[152:155], a[172:175], v[64:67]
    ds_read_b32 v134, v27 offset:1280
    v_mfma_f32_16x16x32_bf16 v[48:51], a[72:75], a[176:179], v[48:51]
    ds_read_b128 v[128:131], v27 offset:1536
    v_mfma_f32_16x16x32_bf16 v[68:71], a[152:155], a[176:179], v[68:71]
    ds_read_b32 v135, v27 offset:1792
    s_waitcnt lgkmcnt(6)
    v_mfma_f32_16x16x32_bf16 v[32:35], a[76:79], a[180:183], v[32:35]
    s_mul_i32 s98, s28, 13312
    s_add_u32 m0, s98, 107520
    s_add_u32 s98, s54, m0
    buffer_load_dwordx4 v8, s[40:43], s98 offen sc1 lds
    s_waitcnt lgkmcnt(0)
    v_mfma_f32_16x16x32_bf16 v[52:55], a[156:159], a[180:183], v[52:55]
    v_add_f32 v116, v116, v120
    v_add_f32 v124, v124, v128
    v_mfma_f32_16x16x32_bf16 v[36:39], a[76:79], a[184:187], v[36:39]
    v_add_f32 v136, v116, v124
    v_add_f32 v117, v117, v121
    v_mfma_f32_16x16x32_bf16 v[56:59], a[156:159], a[184:187], v[56:59]
    v_add_f32 v125, v125, v129
    v_mfma_f32_16x16x32_bf16 v[40:43], a[76:79], a[188:191], v[40:43]
    v_add_f32 v137, v117, v125
    v_add_f32 v118, v118, v122
    v_mfma_f32_16x16x32_bf16 v[60:63], a[156:159], a[188:191], v[60:63]
    v_add_f32 v126, v126, v130
    v_add_f32 v138, v118, v126
    v_mfma_f32_16x16x32_bf16 v[44:47], a[76:79], a[192:195], v[44:47]
    v_add_f32 v119, v119, v123
    v_mfma_f32_16x16x32_bf16 v[64:67], a[156:159], a[192:195], v[64:67]
    v_add_f32 v127, v127, v131
    v_add_f32 v139, v119, v127
    v_mfma_f32_16x16x32_bf16 v[48:51], a[76:79], a[196:199], v[48:51]
    v_add_f32 v132, v132, v133
    v_add_f32 v134, v134, v135
    v_mfma_f32_16x16x32_bf16 v[68:71], a[156:159], a[196:199], v[68:71]
    v_add_f32 v140, v132, v134
    s_nop 8
    v_pk_mul_f32 v[72:73], v[104:105], v[136:137] op_sel:[0,0] op_sel_hi:[1,0]
    v_pk_mul_f32 v[74:75], v[106:107], v[136:137] op_sel:[0,0] op_sel_hi:[1,0]
    v_pk_fma_f32 v[32:33], v[32:33], v[96:97], v[72:73] neg_lo:[0,0,1] neg_hi:[0,0,1]
    v_pk_fma_f32 v[34:35], v[34:35], v[98:99], v[74:75] neg_lo:[0,0,1] neg_hi:[0,0,1]
    v_pk_mul_f32 v[72:73], v[32:33], s[94:95]
    v_pk_mul_f32 v[74:75], v[34:35], s[94:95]
    v_max_f32 v76, 0, v32
    v_max_f32 v77, 0, v33
    v_max_f32 v78, 0, v34
    v_max_f32 v79, 0, v35
    v_exp_f32_e64 v72, v72 clamp
    v_exp_f32_e64 v73, v73 clamp
    v_exp_f32_e64 v74, v74 clamp
    v_exp_f32_e64 v75, v75 clamp
    v_pk_add_f32 v[76:77], v[76:77], s[96:97]
    v_pk_add_f32 v[78:79], v[78:79], s[96:97]
    v_pk_add_f32 v[32:33], v[72:73], v[76:77]
    v_pk_add_f32 v[34:35], v[74:75], v[78:79]
    v_cvt_pk_bf16_f32 v116, v32, v33
    v_cvt_pk_bf16_f32 v117, v34, v35
    s_mul_i32 s98, s28, 13312
    s_add_u32 m0, s98, 108544
    s_add_u32 s98, s54, m0
    buffer_load_dwordx4 v8, s[40:43], s98 offen sc1 lds
    v_pk_mul_f32 v[72:73], v[108:109], v[136:137] op_sel:[0,0] op_sel_hi:[1,0]
    v_pk_mul_f32 v[74:75], v[110:111], v[136:137] op_sel:[0,0] op_sel_hi:[1,0]
    v_pk_fma_f32 v[52:53], v[52:53], v[100:101], v[72:73] neg_lo:[0,0,1] neg_hi:[0,0,1]
    v_pk_fma_f32 v[54:55], v[54:55], v[102:103], v[74:75] neg_lo:[0,0,1] neg_hi:[0,0,1]
    v_pk_mul_f32 v[72:73], v[52:53], s[94:95]
    v_pk_mul_f32 v[74:75], v[54:55], s[94:95]
    v_max_f32 v76, 0, v52
    v_max_f32 v77, 0, v53
    v_max_f32 v78, 0, v54
    v_max_f32 v79, 0, v55
    v_exp_f32_e64 v72, v72 clamp
    v_exp_f32_e64 v73, v73 clamp
    v_exp_f32_e64 v74, v74 clamp
    v_exp_f32_e64 v75, v75 clamp
    v_pk_add_f32 v[76:77], v[76:77], s[96:97]
    v_pk_add_f32 v[78:79], v[78:79], s[96:97]
    v_pk_add_f32 v[52:53], v[72:73], v[76:77]
    v_pk_add_f32 v[54:55], v[74:75], v[78:79]
    v_cvt_pk_bf16_f32 v118, v52, v53
    v_cvt_pk_bf16_f32 v119, v54, v55
    s_mul_i32 s98, s28, 13312
    s_add_u32 m0, s98, 109568
    s_add_u32 s98, s54, m0
    buffer_load_dwordx4 v8, s[40:43], s98 offen sc1 lds
    v_pk_mul_f32 v[72:73], v[104:105], v[136:137] op_sel:[0,1] op_sel_hi:[1,1]
    v_pk_mul_f32 v[74:75], v[106:107], v[136:137] op_sel:[0,1] op_sel_hi:[1,1]
    v_pk_fma_f32 v[36:37], v[36:37], v[96:97], v[72:73] neg_lo:[0,0,1] neg_hi:[0,0,1]
    v_pk_fma_f32 v[38:39], v[38:39], v[98:99], v[74:75] neg_lo:[0,0,1] neg_hi:[0,0,1]
    v_pk_mul_f32 v[72:73], v[36:37], s[94:95]
    v_pk_mul_f32 v[74:75], v[38:39], s[94:95]
    v_max_f32 v76, 0, v36
    v_max_f32 v77, 0, v37
    v_max_f32 v78, 0, v38
    v_max_f32 v79, 0, v39
    v_exp_f32_e64 v72, v72 clamp
    v_exp_f32_e64 v73, v73 clamp
    v_exp_f32_e64 v74, v74 clamp
    v_exp_f32_e64 v75, v75 clamp
    v_pk_add_f32 v[76:77], v[76:77], s[96:97]
    v_pk_add_f32 v[78:79], v[78:79], s[96:97]
    v_pk_add_f32 v[36:37], v[72:73], v[76:77]
    v_pk_add_f32 v[38:39], v[74:75], v[78:79]
    v_cvt_pk_bf16_f32 v120, v36, v37
    v_cvt_pk_bf16_f32 v121, v38, v39
    s_mul_i32 s98, s28, 13312
    s_add_u32 m0, s98, 110592
    s_add_u32 s98, s54, m0
    buffer_load_dwordx4 v8, s[40:43], s98 offen sc1 lds
    v_pk_mul_f32 v[72:73], v[108:109], v[136:137] op_sel:[0,1] op_sel_hi:[1,1]
    v_pk_mul_f32 v[74:75], v[110:111], v[136:137] op_sel:[0,1] op_sel_hi:[1,1]
    v_pk_fma_f32 v[56:57], v[56:57], v[100:101], v[72:73] neg_lo:[0,0,1] neg_hi:[0,0,1]
    v_pk_fma_f32 v[58:59], v[58:59], v[102:103], v[74:75] neg_lo:[0,0,1] neg_hi:[0,0,1]
    v_pk_mul_f32 v[72:73], v[56:57], s[94:95]
    v_pk_mul_f32 v[74:75], v[58:59], s[94:95]
    v_max_f32 v76, 0, v56
    v_max_f32 v77, 0, v57
    v_max_f32 v78, 0, v58
    v_max_f32 v79, 0, v59
    v_exp_f32_e64 v72, v72 clamp
    v_exp_f32_e64 v73, v73 clamp
    v_exp_f32_e64 v74, v74 clamp
    v_exp_f32_e64 v75, v75 clamp
    v_pk_add_f32 v[76:77], v[76:77], s[96:97]
    v_pk_add_f32 v[78:79], v[78:79], s[96:97]
    v_pk_add_f32 v[56:57], v[72:73], v[76:77]
    v_pk_add_f32 v[58:59], v[74:75], v[78:79]
    v_cvt_pk_bf16_f32 v122, v56, v57
    v_cvt_pk_bf16_f32 v123, v58, v59
    s_mul_i32 s98, s28, 13312
    s_add_u32 m0, s98, 111616
    s_add_u32 s98, s54, m0
    buffer_load_dwordx4 v8, s[40:43], s98 offen sc1 lds
    v_pk_mul_f32 v[72:73], v[104:105], v[138:139] op_sel:[0,0] op_sel_hi:[1,0]
    v_pk_mul_f32 v[74:75], v[106:107], v[138:139] op_sel:[0,0] op_sel_hi:[1,0]
    v_pk_fma_f32 v[40:41], v[40:41], v[96:97], v[72:73] neg_lo:[0,0,1] neg_hi:[0,0,1]
    v_pk_fma_f32 v[42:43], v[42:43], v[98:99], v[74:75] neg_lo:[0,0,1] neg_hi:[0,0,1]
    v_pk_mul_f32 v[72:73], v[40:41], s[94:95]
    v_pk_mul_f32 v[74:75], v[42:43], s[94:95]
    v_max_f32 v76, 0, v40
    v_max_f32 v77, 0, v41
    v_max_f32 v78, 0, v42
    v_max_f32 v79, 0, v43
    v_exp_f32_e64 v72, v72 clamp
    v_exp_f32_e64 v73, v73 clamp
    v_exp_f32_e64 v74, v74 clamp
    v_exp_f32_e64 v75, v75 clamp
    v_pk_add_f32 v[76:77], v[76:77], s[96:97]
    v_pk_add_f32 v[78:79], v[78:79], s[96:97]
    v_pk_add_f32 v[72:73], v[72:73], v[76:77]
    v_pk_add_f32 v[74:75], v[74:75], v[78:79]
    v_cndmask_b32 v40, v40, v72, s[66:67]
    v_cndmask_b32 v41, v41, v73, s[66:67]
    v_cndmask_b32 v42, v42, v74, s[66:67]
    v_cndmask_b32 v43, v43, v75, s[66:67]
    v_cvt_pk_bf16_f32 v124, v40, v41
    v_cvt_pk_bf16_f32 v125, v42, v43
    s_mul_i32 s98, s28, 13312
    s_add_u32 m0, s98, 112640
    s_add_u32 s98, s54, m0
    buffer_load_dwordx4 v8, s[40:43], s98 offen sc1 lds
    v_pk_mul_f32 v[72:73], v[108:109], v[138:139] op_sel:[0,0] op_sel_hi:[1,0]
    v_pk_mul_f32 v[74:75], v[110:111], v[138:139] op_sel:[0,0] op_sel_hi:[1,0]
    v_pk_fma_f32 v[60:61], v[60:61], v[100:101], v[72:73] neg_lo:[0,0,1] neg_hi:[0,0,1]
    v_pk_fma_f32 v[62:63], v[62:63], v[102:103], v[74:75] neg_lo:[0,0,1] neg_hi:[0,0,1]
    v_pk_mul_f32 v[72:73], v[60:61], s[94:95]
    v_pk_mul_f32 v[74:75], v[62:63], s[94:95]
    v_max_f32 v76, 0, v60
    v_max_f32 v77, 0, v61
    v_max_f32 v78, 0, v62
    v_max_f32 v79, 0, v63
    v_exp_f32_e64 v72, v72 clamp
    v_exp_f32_e64 v73, v73 clamp
    v_exp_f32_e64 v74, v74 clamp
    v_exp_f32_e64 v75, v75 clamp
    v_pk_add_f32 v[76:77], v[76:77], s[96:97]
    v_pk_add_f32 v[78:79], v[78:79], s[96:97]
    v_pk_add_f32 v[72:73], v[72:73], v[76:77]
    v_pk_add_f32 v[74:75], v[74:75], v[78:79]
    v_cndmask_b32 v60, v60, v72, s[66:67]
    v_cndmask_b32 v61, v61, v73, s[66:67]
    v_cndmask_b32 v62, v62, v74, s[66:67]
    v_cndmask_b32 v63, v63, v75, s[66:67]
    v_cvt_pk_bf16_f32 v126, v60, v61
    v_cvt_pk_bf16_f32 v127, v62, v63
    s_cmp_eq_u32 s28, 3
    s_cbranch_scc1 L_noq
    s_mul_i32 s98, s28, 13312
    s_add_u32 m0, s98, 113664
    s_add_u32 s98, s54, m0
    buffer_load_dwordx4 v8, s[40:43], s98 offen sc1 lds
    s_mul_i32 s98, s28, 13312
    s_add_u32 m0, s98, 114688
    s_add_u32 s98, s54, m0
    buffer_load_dwordx4 v8, s[40:43], s98 offen sc1 lds
L_noq:
    v_pk_mul_f32 v[72:73], v[104:105], v[138:139] op_sel:[0,1] op_sel_hi:[1,1]
    v_pk_mul_f32 v[74:75], v[106:107], v[138:139] op_sel:[0,1] op_sel_hi:[1,1]
    v_pk_fma_f32 v[44:45], v[44:45], v[96:97], v[72:73] neg_lo:[0,0,1] neg_hi:[0,0,1]
    v_pk_fma_f32 v[46:47], v[46:47], v[98:99], v[74:75] neg_lo:[0,0,1] neg_hi:[0,0,1]
    v_cvt_pk_bf16_f32 v128, v44, v45
    v_cvt_pk_bf16_f32 v129, v46, v47
    v_pk_mul_f32 v[72:73], v[108:109], v[138:139] op_sel:[0,1] op_sel_hi:[1,1]
    v_pk_mul_f32 v[74:75], v[110:111], v[138:139] op_sel:[0,1] op_sel_hi:[1,1]
    v_pk_fma_f32 v[64:65], v[64:65], v[100:101], v[72:73] neg_lo:[0,0,1] neg_hi:[0,0,1]
    v_pk_fma_f32 v[66:67], v[66:67], v[102:103], v[74:75] neg_lo:[0,0,1] neg_hi:[0,0,1]
    v_cvt_pk_bf16_f32 v130, v64, v65
    v_cvt_pk_bf16_f32 v131, v66, v67
    v_pk_mul_f32 v[72:73], v[104:105], v[140:141] op_sel:[0,0] op_sel_hi:[1,0]
    v_pk_mul_f32 v[74:75], v[106:107], v[140:141] op_sel:[0,0] op_sel_hi:[1,0]
    v_pk_fma_f32 v[48:49], v[48:49], v[96:97], v[72:73] neg_lo:[0,0,1] neg_hi:[0,0,1]
    v_pk_fma_f32 v[50:51], v[50:51], v[98:99], v[74:75] neg_lo:[0,0,1] neg_hi:[0,0,1]
    v_cvt_pk_bf16_f32 v132, v48, v49
    v_cvt_pk_bf16_f32 v133, v50, v51
    v_pk_mul_f32 v[72:73], v[108:109], v[140:141] op_sel:[0,0] op_sel_hi:[1,0]
    v_pk_mul_f32 v[74:75], v[110:111], v[140:141] op_sel:[0,0] op_sel_hi:[1,0]
    v_pk_fma_f32 v[68:69], v[68:69], v[100:101], v[72:73] neg_lo:[0,0,1] neg_hi:[0,0,1]
    v_pk_fma_f32 v[70:71], v[70:71], v[102:103], v[74:75] neg_lo:[0,0,1] neg_hi:[0,0,1]
    v_cvt_pk_bf16_f32 v134, v68, v69
    v_cvt_pk_bf16_f32 v135, v70, v71
    s_nop 1
    v_mfma_f32_16x16x32_bf16 v[32:35], v[116:119], v[124:127], 0
    v_mfma_f32_16x16x32_bf16 v[36:39], v[116:119], v[128:131], 0
    v_mfma_f32_16x16x32_bf16 v[40:43], v[120:123], v[124:127], 0
    v_mfma_f32_16x16x32_bf16 v[44:47], v[120:123], v[128:131], 0
    v_mfma_f32_16x16x32_bf16 v[48:51], v[120:123], v[132:135], 0
    v_mfma_f32_16x16x32_bf16 v[52:55], v[124:127], v[128:131], 0
    v_mfma_f32_16x16x32_bf16 v[56:59], v[124:127], v[132:135], 0
    v_mfma_f32_16x16x32_bf16 v[60:63], v[116:119], a[200:203], 0
    v_mfma_f32_16x16x32_bf16 v[64:67], v[120:123], a[200:203], 0
    v_mfma_f32_16x16x32_bf16 v[68:71], v[124:127], a[200:203], 0
    s_mul_i32 s3, s28, 10240
    v_add_u32 v27, s3, v8
    ds_write_b128 v27, v[32:35] offset:0
    ds_write_b128 v27, v[36:39] offset:1024
    ds_write_b128 v27, v[40:43] offset:2048
    ds_write_b128 v27, v[44:47] offset:3072
    ds_write_b128 v27, v[48:51] offset:4096
    ds_write_b128 v27, v[52:55] offset:5120
    ds_write_b128 v27, v[56:59] offset:6144
    ds_write_b128 v27, v[60:63] offset:7168
    ds_write_b128 v27, v[64:67] offset:8192
    ds_write_b128 v27, v[68:71] offset:9216
    s_lshl_b32 s3, s27, 4
    s_add_u32 s3, s3, s26
    s_lshl_b32 s3, s3, 12
    s_add_u32 s3, s3, 7946240
    v_cmp_gt_u32 vcc, 216, v0
    s_nop 1
    v_cndmask_b32 v9, v2, v9, vcc
    s_waitcnt lgkmcnt(0)
    s_barrier
    ds_read_b128 v[56:59], v24 offset:0
    ds_read_b128 v[60:63], v24 offset:10240
    ds_read_b128 v[64:67], v24 offset:20480
    ds_read_b128 v[68:71], v24 offset:30720
    s_waitcnt lgkmcnt(0)
    v_pk_add_f32 v[56:57], v[56:57], v[60:61]
    v_pk_add_f32 v[64:65], v[64:65], v[68:69]
    v_pk_add_f32 v[58:59], v[58:59], v[62:63]
    v_pk_add_f32 v[66:67], v[66:67], v[70:71]
    v_pk_add_f32 v[56:57], v[56:57], v[64:65]
    v_pk_add_f32 v[58:59], v[58:59], v[66:67]
    s_nop 0
    buffer_store_dwordx4 v[56:59], v9, s[40:43], s3 offen sc1
    v_lshlrev_b32 v31, 3, v1
    buffer_load_dwordx2 v[92:93], v31, s[40:43], s59 offen sc1
    s_lshr_b32 s48, s27, 3
    s_and_b32 s49, s27, 7
    v_lshrrev_b32 v13, 1, v11
    v_lshlrev_b32 v13, 8, v13
    v_lshl_add_u32 v13, v10, 2, v13
    v_and_b32 v28, 1, v11
    v_lshl_add_u32 v13, v28, 3, v13
    v_mul_u32_u24 v14, 320, v10
    v_lshl_add_u32 v15, v11, 3, v14
    v_lshl_add_u32 v14, v11, 4, v14
    s_lshl_b32 s50, s48, 2
    s_add_u32 s50, s50, s28
    s_lshl_b32 s3, s26, 3
    s_add_u32 s3, s3, s50
    s_mul_i32 s51, s3, 20480
    s_mul_i32 s3, s49, 160
    s_add_u32 s51, s51, s3
    s_mul_i32 s53, s27, 27
    s_lshr_b32 s53, s53, 2
    s_mul_i32 s55, s27, 143360
    s_add_u32 s55, s55, 3031040
    s_mov_b32 s36, s14
    s_and_b32 s37, s15, 0xffff
    s_mov_b32 s38, 3456
    s_mov_b32 s39, 0x20000
    v_lshlrev_b32 v23, 4, v11
    v_lshl_add_u32 v26, v10, 4, v23
    s_lshl_b32 s62, s27, 2
    s_add_u32 s62, s62, s28
    s_lshl_b32 s62, s62, 7
    s_lshl_b32 s56, s26, 7
    s_add_u32 s56, s56, 8192
    v_mov_b32 v27, s62
    v_mov_b32 v28, s56
    v_cndmask_b32 v17, v27, v28, s[88:89]
    v_add_u32 v17, v17, v10
    s_lshl_b32 s3, s26, 2
    s_add_u32 s3, s3, s62
    s_add_u32 s3, s3, 21463040
    s_waitcnt vmcnt(1)
    s_mov_b64 exec, 1
    buffer_store_dword v6, v5, s[40:43], s3 offen sc1
    s_mov_b64 exec, -1
    s_barrier
    s_waitcnt vmcnt(1)
    s_mov_b32 s78, 0
L_fu:
    v_cmp_ne_u32 vcc, s76, v92
    v_cmp_ne_u32 s[84:85], s76, v93
    s_or_b64 vcc, vcc, s[84:85]
    s_cbranch_scc0 L_fu_ok
    s_add_u32 s78, s78, 1
    s_cmp_ge_u32 s78, 32768
    s_cbranch_scc1 L_fu_ok
    buffer_load_dwordx2 v[92:93], v31, s[40:43], s59 offen sc1
    s_waitcnt vmcnt(0)
    s_branch L_fu
L_fu_ok:
    v_lshlrev_b32 v31, 5, v1
    s_add_u32 s98, s30, T2_tab-L_pc
    s_addc_u32 s99, s31, 0
    global_load_dwordx4 v[146:149], v31, s[98:99]
    global_load_dwordx2 v[150:151], v31, s[98:99] offset:16
    ds_read_b128 a[160:163], v86 offset:0
    ds_read_b128 a[164:167], v86 offset:1024
    ds_read_b128 a[168:171], v90 offset:0
    ds_read_b128 a[172:175], v87 offset:0
    ds_read_b128 a[176:179], v87 offset:1024
    ds_read_b128 a[180:183], v91 offset:0
    s_mov_b32 s56, 21463040
    s_waitcnt lgkmcnt(3)
    v_mfma_f32_16x16x32_bf16 v[32:35], a[160:163], a[0:3], 0
    ds_read_b128 a[184:187], v88 offset:0
    buffer_load_dwordx4 v[156:159], v8, s[40:43], s65 offen offset:0 sc1
    v_mfma_f32_16x16x32_bf16 v[44:47], a[160:163], a[80:83], 0
    ds_read_b128 a[188:191], v88 offset:1024
    v_mfma_f32_16x16x32_bf16 a[244:247], a[160:163], a[220:223], 0
    ds_read_b128 a[192:195], v21 offset:0
    v_mfma_f32_16x16x32_bf16 v[36:39], a[164:167], a[0:3], 0
    v_mfma_f32_16x16x32_bf16 v[48:51], a[164:167], a[80:83], 0
    v_mfma_f32_16x16x32_bf16 a[244:247], a[164:167], a[224:227], a[244:247]
    v_mfma_f32_16x16x32_bf16 v[40:43], a[168:171], a[0:3], 0
    v_mfma_f32_16x16x32_bf16 v[52:55], a[168:171], a[80:83], 0
    v_mfma_f32_16x16x32_bf16 a[244:247], a[168:171], a[228:231], a[244:247]
    s_waitcnt lgkmcnt(3)
    v_mfma_f32_16x16x32_bf16 v[32:35], a[172:175], a[4:7], v[32:35]
    ds_read_b128 a[160:163], v89 offset:0
    buffer_load_dwordx4 v[160:163], v8, s[40:43], s65 offen offset:1024 sc1
    v_mfma_f32_16x16x32_bf16 v[44:47], a[172:175], a[84:87], v[44:47]
    ds_read_b128 a[164:167], v89 offset:1024
    v_mfma_f32_16x16x32_bf16 v[36:39], a[176:179], a[4:7], v[36:39]
    ds_read_b128 a[168:171], v22 offset:0
    v_mfma_f32_16x16x32_bf16 v[48:51], a[176:179], a[84:87], v[48:51]
    v_mfma_f32_16x16x32_bf16 v[40:43], a[180:183], a[4:7], v[40:43]
    v_mfma_f32_16x16x32_bf16 v[52:55], a[180:183], a[84:87], v[52:55]
    s_waitcnt lgkmcnt(3)
    v_mfma_f32_16x16x32_bf16 v[32:35], a[184:187], a[8:11], v[32:35]
    ds_read_b128 a[172:175], v86 offset:10240
    buffer_load_dwordx4 v[164:167], v8, s[40:43], s65 offen offset:2048 sc1
    v_mfma_f32_16x16x32_bf16 v[44:47], a[184:187], a[88:91], v[44:47]
    ds_read_b128 a[176:179], v86 offset:11264
    v_mfma_f32_16x16x32_bf16 v[36:39], a[188:191], a[8:11], v[36:39]
    ds_read_b128 a[180:183], v90 offset:10240
    v_mfma_f32_16x16x32_bf16 v[48:51], a[188:191], a[88:91], v[48:51]
    v_mfma_f32_16x16x32_bf16 v[40:43], a[192:195], a[8:11], v[40:43]
    v_mfma_f32_16x16x32_bf16 v[52:55], a[192:195], a[88:91], v[52:55]
    s_waitcnt lgkmcnt(3)
    v_mfma_f32_16x16x32_bf16 v[32:35], a[160:163], a[12:15], v[32:35]
    ds_read_b128 a[184:187], v87 offset:10240
    buffer_load_dwordx4 v[168:171], v8, s[40:43], s65 offen offset:3072 sc1
    v_mfma_f32_16x16x32_bf16 v[44:47], a[160:163], a[92:95], v[44:47]
    ds_read_b128 a[188:191], v87 offset:11264
    v_mfma_f32_16x16x32_bf16 v[36:39], a[164:167], a[12:15], v[36:39]
    ds_read_b128 a[192:195], v91 offset:10240
    v_mfma_f32_16x16x32_bf16 v[48:51], a[164:167], a[92:95], v[48:51]
    v_mfma_f32_16x16x32_bf16 v[40:43], a[168:171], a[12:15], v[40:43]
    v_mfma_f32_16x16x32_bf16 v[52:55], a[168:171], a[92:95], v[52:55]
    s_waitcnt lgkmcnt(3)
    v_mfma_f32_16x16x32_bf16 v[32:35], a[172:175], a[16:19], v[32:35]
    ds_read_b128 a[160:163], v88 offset:10240
    buffer_load_dwordx4 v[172:175], v12, s[40:43], s65 offen offset:0 sc1
    s_add_u32 s65, s65, 20480
    v_mfma_f32_16x16x32_bf16 v[44:47], a[172:175], a[96:99], v[44:47]
    ds_read_b128 a[164:167], v88 offset:11264
    v_mfma_f32_16x16x32_bf16 a[244:247], a[172:175], a[220:223], a[244:247]
    ds_read_b128 a[168:171], v21 offset:10240
    v_mfma_f32_16x16x32_bf16 v[36:39], a[176:179], a[16:19], v[36:39]
    v_mfma_f32_16x16x32_bf16 v[48:51], a[176:179], a[96:99], v[48:51]
    v_mfma_f32_16x16x32_bf16 a[244:247], a[176:179], a[224:227], a[244:247]
    v_mfma_f32_16x16x32_bf16 v[40:43], a[180:183], a[16:19], v[40:43]
    v_mfma_f32_16x16x32_bf16 v[52:55], a[180:183], a[96:99], v[52:55]
    v_mfma_f32_16x16x32_bf16 a[244:247], a[180:183], a[228:231], a[244:247]
    s_waitcnt lgkmcnt(3)
    v_mfma_f32_16x16x32_bf16 v[32:35], a[184:187], a[20:23], v[32:35]
    ds_read_b128 a[172:175], v89 offset:10240
    buffer_load_dwordx4 v[176:179], v8, s[40:43], s65 offen offset:0 sc1
    v_mfma_f32_16x16x32_bf16 v[44:47], a[184:187], a[100:103], v[44:47]
    ds_read_b128 a[176:179], v89 offset:11264
    v_mfma_f32_16x16x32_bf16 v[36:39], a[188:191], a[20:23], v[36:39]
    ds_read_b128 a[180:183], v22 offset:10240
    v_mfma_f32_16x16x32_bf16 v[48:51], a[188:191], a[100:103], v[48:51]
    v_mfma_f32_16x16x32_bf16 v[40:43], a[192:195], a[20:23], v[40:43]
    v_mfma_f32_16x16x32_bf16 v[52:55], a[192:195], a[100:103], v[52:55]
    s_waitcnt lgkmcnt(3)
    v_mfma_f32_16x16x32_bf16 v[32:35], a[160:163], a[24:27], v[32:35]
    ds_read_b128 a[184:187], v86 offset:20480
    buffer_load_dwordx4 v[180:183], v8, s[40:43], s65 offen offset:1024 sc1
    v_mfma_f32_16x16x32_bf16 v[44:47], a[160:163], a[104:107], v[44:47]
    ds_read_b128 a[188:191], v86 offset:21504
    v_mfma_f32_16x16x32_bf16 v[36:39], a[164:167], a[24:27], v[36:39]
    ds_read_b128 a[192:195], v90 offset:20480
    v_mfma_f32_16x16x32_bf16 v[48:51], a[164:167], a[104:107], v[48:51]
    v_mfma_f32_16x16x32_bf16 v[40:43], a[168:171], a[24:27], v[40:43]
    v_mfma_f32_16x16x32_bf16 v[52:55], a[168:171], a[104:107], v[52:55]
    s_waitcnt lgkmcnt(3)
    v_mfma_f32_16x16x32_bf16 v[32:35], a[172:175], a[28:31], v[32:35]
    ds_read_b128 a[160:163], v87 offset:20480
    buffer_load_dwordx4 v[184:187], v8, s[40:43], s65 offen offset:2048 sc1
    v_mfma_f32_16x16x32_bf16 v[44:47], a[172:175], a[108:111], v[44:47]
    ds_read_b128 a[164:167], v87 offset:21504
    v_mfma_f32_16x16x32_bf16 v[36:39], a[176:179], a[28:31], v[36:39]
    ds_read_b128 a[168:171], v91 offset:20480
    v_mfma_f32_16x16x32_bf16 v[48:51], a[176:179], a[108:111], v[48:51]
    v_mfma_f32_16x16x32_bf16 v[40:43], a[180:183], a[28:31], v[40:43]
    v_mfma_f32_16x16x32_bf16 v[52:55], a[180:183], a[108:111], v[52:55]
    s_waitcnt lgkmcnt(3)
    v_mfma_f32_16x16x32_bf16 v[32:35], a[184:187], a[32:35], v[32:35]
    ds_read_b128 a[172:175], v88 offset:20480
    buffer_load_dwordx4 v[188:191], v8, s[40:43], s65 offen offset:3072 sc1
    v_mfma_f32_16x16x32_bf16 v[44:47], a[184:187], a[112:115], v[44:47]
    ds_read_b128 a[176:179], v88 offset:21504
    v_mfma_f32_16x16x32_bf16 a[244:247], a[184:187], a[220:223], a[244:247]
    ds_read_b128 a[180:183], v21 offset:20480
    v_mfma_f32_16x16x32_bf16 v[36:39], a[188:191], a[32:35], v[36:39]
    v_mfma_f32_16x16x32_bf16 v[48:51], a[188:191], a[112:115], v[48:51]
    v_mfma_f32_16x16x32_bf16 a[244:247], a[188:191], a[224:227], a[244:247]
    v_mfma_f32_16x16x32_bf16 v[40:43], a[192:195], a[32:35], v[40:43]
    v_mfma_f32_16x16x32_bf16 v[52:55], a[192:195], a[112:115], v[52:55]
    v_mfma_f32_16x16x32_bf16 a[244:247], a[192:195], a[228:231], a[244:247]
    s_waitcnt lgkmcnt(3)
    v_mfma_f32_16x16x32_bf16 v[32:35], a[160:163], a[36:39], v[32:35]
    ds_read_b128 a[184:187], v89 offset:20480
    buffer_load_dwordx4 v[192:195], v12, s[40:43], s65 offen offset:0 sc1
    s_add_u32 s65, s65, 20480
    v_mfma_f32_16x16x32_bf16 v[44:47], a[160:163], a[116:119], v[44:47]
    ds_read_b128 a[188:191], v89 offset:21504
    v_mfma_f32_16x16x32_bf16 v[36:39], a[164:167], a[36:39], v[36:39]
    ds_read_b128 a[192:195], v22 offset:20480
    v_mfma_f32_16x16x32_bf16 v[48:51], a[164:167], a[116:119], v[48:51]
    v_mfma_f32_16x16x32_bf16 v[40:43], a[168:171], a[36:39], v[40:43]
    v_mfma_f32_16x16x32_bf16 v[52:55], a[168:171], a[116:119], v[52:55]
    s_waitcnt lgkmcnt(3)
    v_mfma_f32_16x16x32_bf16 v[32:35], a[172:175], a[40:43], v[32:35]
    ds_read_b128 a[160:163], v86 offset:30720
    buffer_load_dwordx4 v[196:199], v8, s[40:43], s65 offen offset:0 sc1
    v_mfma_f32_16x16x32_bf16 v[44:47], a[172:175], a[120:123], v[44:47]
    ds_read_b128 a[164:167], v86 offset:31744
    v_mfma_f32_16x16x32_bf16 v[36:39], a[176:179], a[40:43], v[36:39]
    ds_read_b128 a[168:171], v90 offset:30720
    v_mfma_f32_16x16x32_bf16 v[48:51], a[176:179], a[120:123], v[48:51]
    v_mfma_f32_16x16x32_bf16 v[40:43], a[180:183], a[40:43], v[40:43]
    v_mfma_f32_16x16x32_bf16 v[52:55], a[180:183], a[120:123], v[52:55]
    s_waitcnt lgkmcnt(3)
    v_mfma_f32_16x16x32_bf16 v[32:35], a[184:187], a[44:47], v[32:35]
    ds_read_b128 a[172:175], v87 offset:30720
    buffer_load_dwordx4 v[200:203], v8, s[40:43], s65 offen offset:1024 sc1
    v_mfma_f32_16x16x32_bf16 v[44:47], a[184:187], a[124:127], v[44:47]
    ds_read_b128 a[176:179], v87 offset:31744
    v_mfma_f32_16x16x32_bf16 v[36:39], a[188:191], a[44:47], v[36:39]
    ds_read_b128 a[180:183], v91 offset:30720
    v_mfma_f32_16x16x32_bf16 v[48:51], a[188:191], a[124:127], v[48:51]
    v_mfma_f32_16x16x32_bf16 v[40:43], a[192:195], a[44:47], v[40:43]
    v_mfma_f32_16x16x32_bf16 v[52:55], a[192:195], a[124:127], v[52:55]
    s_waitcnt lgkmcnt(3)
    v_mfma_f32_16x16x32_bf16 v[32:35], a[160:163], a[48:51], v[32:35]
    ds_read_b128 a[184:187], v88 offset:30720
    buffer_load_dwordx4 v[204:207], v8, s[40:43], s65 offen offset:2048 sc1
    v_mfma_f32_16x16x32_bf16 v[44:47], a[160:163], a[128:131], v[44:47]
    ds_read_b128 a[188:191], v88 offset:31744
    v_mfma_f32_16x16x32_bf16 a[244:247], a[160:163], a[220:223], a[244:247]
    ds_read_b128 a[192:195], v21 offset:30720
    v_mfma_f32_16x16x32_bf16 v[36:39], a[164:167], a[48:51], v[36:39]
    v_mfma_f32_16x16x32_bf16 v[48:51], a[164:167], a[128:131], v[48:51]
    v_mfma_f32_16x16x32_bf16 a[244:247], a[164:167], a[224:227], a[244:247]
    v_mfma_f32_16x16x32_bf16 v[40:43], a[168:171], a[48:51], v[40:43]
    v_mfma_f32_16x16x32_bf16 v[52:55], a[168:171], a[128:131], v[52:55]
    v_mfma_f32_16x16x32_bf16 a[244:247], a[168:171], a[228:231], a[244:247]
    s_waitcnt lgkmcnt(3)
    v_mfma_f32_16x16x32_bf16 v[32:35], a[172:175], a[52:55], v[32:35]
    ds_read_b128 a[160:163], v89 offset:30720
    buffer_load_dwordx4 v[208:211], v8, s[40:43], s65 offen offset:3072 sc1
    v_mfma_f32_16x16x32_bf16 v[44:47], a[172:175], a[132:135], v[44:47]
    ds_read_b128 a[164:167], v89 offset:31744
    v_mfma_f32_16x16x32_bf16 v[36:39], a[176:179], a[52:55], v[36:39]
    ds_read_b128 a[168:171], v22 offset:30720
    v_mfma_f32_16x16x32_bf16 v[48:51], a[176:179], a[132:135], v[48:51]
    v_mfma_f32_16x16x32_bf16 v[40:43], a[180:183], a[52:55], v[40:43]
    v_mfma_f32_16x16x32_bf16 v[52:55], a[180:183], a[132:135], v[52:55]
    s_waitcnt lgkmcnt(3)
    v_mfma_f32_16x16x32_bf16 v[32:35], a[184:187], a[56:59], v[32:35]
    ds_read_b128 a[172:175], v86 offset:40960
    buffer_load_dwordx4 v[212:215], v12, s[40:43], s65 offen offset:0 sc1
    s_add_u32 s65, s65, 20480
    v_mfma_f32_16x16x32_bf16 v[44:47], a[184:187], a[136:139], v[44:47]
    ds_read_b128 a[176:179], v86 offset:41984
    v_mfma_f32_16x16x32_bf16 v[36:39], a[188:191], a[56:59], v[36:39]
    ds_read_b128 a[180:183], v90 offset:40960
    v_mfma_f32_16x16x32_bf16 v[48:51], a[188:191], a[136:139], v[48:51]
    v_mfma_f32_16x16x32_bf16 v[40:43], a[192:195], a[56:59], v[40:43]
    v_mfma_f32_16x16x32_bf16 v[52:55], a[192:195], a[136:139], v[52:55]
    s_waitcnt lgkmcnt(3)
    v_mfma_f32_16x16x32_bf16 v[32:35], a[160:163], a[60:63], v[32:35]
    ds_read_b128 a[184:187], v87 offset:40960
    buffer_load_dwordx4 v[216:219], v8, s[40:43], s65 offen offset:0 sc1
    v_mfma_f32_16x16x32_bf16 v[44:47], a[160:163], a[140:143], v[44:47]
    ds_read_b128 a[188:191], v87 offset:41984
    v_mfma_f32_16x16x32_bf16 v[36:39], a[164:167], a[60:63], v[36:39]
    ds_read_b128 a[192:195], v91 offset:40960
    v_mfma_f32_16x16x32_bf16 v[48:51], a[164:167], a[140:143], v[48:51]
    v_mfma_f32_16x16x32_bf16 v[40:43], a[168:171], a[60:63], v[40:43]
    v_mfma_f32_16x16x32_bf16 v[52:55], a[168:171], a[140:143], v[52:55]
    s_waitcnt lgkmcnt(3)
    v_mfma_f32_16x16x32_bf16 v[32:35], a[172:175], a[64:67], v[32:35]
    ds_read_b128 a[160:163], v88 offset:40960
    v_mfma_f32_16x16x32_bf16 v[44:47], a[172:175], a[144:147], v[44:47]
    ds_read_b128 a[164:167], v88 offset:41984
    v_mfma_f32_16x16x32_bf16 a[244:247], a[172:175], a[220:223], a[244:247]
    ds_read_b128 a[168:171], v21 offset:40960
    v_mfma_f32_16x16x32_bf16 v[36:39], a[176:179], a[64:67], v[36:39]
    v_mfma_f32_16x16x32_bf16 v[48:51], a[176:179], a[144:147], v[48:51]
    v_mfma_f32_16x16x32_bf16 a[244:247], a[176:179], a[224:227], a[244:247]
    v_mfma_f32_16x16x32_bf16 v[40:43], a[180:183], a[64:67], v[40:43]
    v_mfma_f32_16x16x32_bf16 v[52:55], a[180:183], a[144:147], v[52:55]
    v_mfma_f32_16x16x32_bf16 a[244:247], a[180:183], a[228:231], a[244:247]
    s_waitcnt lgkmcnt(3)
    v_mfma_f32_16x16x32_bf16 v[32:35], a[184:187], a[68:71], v[32:35]
    ds_read_b128 a[172:175], v89 offset:40960
    buffer_load_dword v16, v17, s[40:43], s56 offen sc1
    v_mfma_f32_16x16x32_bf16 v[44:47], a[184:187], a[148:151], v[44:47]
    ds_read_b128 a[176:179], v89 offset:41984
    s_lshl_b32 s3, s28, 9
    v_mfma_f32_16x16x32_bf16 v[36:39], a[188:191], a[68:71], v[36:39]
    ds_read_b128 a[180:183], v22 offset:40960
    s_add_u32 s3, s3, 161792
    v_mfma_f32_16x16x32_bf16 v[48:51], a[188:191], a[148:151], v[48:51]
    v_add_u32 v27, s3, v26
    v_mfma_f32_16x16x32_bf16 v[40:43], a[192:195], a[68:71], v[40:43]
    s_mov_b64 exec, s[66:67]
    ds_write_b128 v27, a[244:247]
    s_mov_b64 exec, -1
    v_mfma_f32_16x16x32_bf16 v[52:55], a[192:195], a[148:151], v[52:55]
    s_waitcnt lgkmcnt(0)
    s_barrier
    s_waitcnt lgkmcnt(4)
    v_mfma_f32_16x16x32_bf16 v[32:35], a[160:163], a[72:75], v[32:35]
    v_add_u32 v30, 161792, v23
    ds_read_b128 v[56:59], v30 offset:0
    v_mfma_f32_16x16x32_bf16 v[44:47], a[160:163], a[152:155], v[44:47]
    ds_read_b128 v[60:63], v30 offset:64
    ds_read_b128 v[64:67], v30 offset:128
    v_mfma_f32_16x16x32_bf16 v[36:39], a[164:167], a[72:75], v[36:39]
    ds_read_b128 v[68:71], v30 offset:512
    v_mfma_f32_16x16x32_bf16 v[48:51], a[164:167], a[152:155], v[48:51]
    ds_read_b128 v[72:75], v30 offset:576
    ds_read_b128 v[76:79], v30 offset:640
    v_mfma_f32_16x16x32_bf16 v[40:43], a[168:171], a[72:75], v[40:43]
    ds_read_b128 v[96:99], v30 offset:1024
    ds_read_b128 v[100:103], v30 offset:1088
    v_mfma_f32_16x16x32_bf16 v[52:55], a[168:171], a[152:155], v[52:55]
    ds_read_b128 v[104:107], v30 offset:1152
    s_waitcnt lgkmcnt(10)
    v_mfma_f32_16x16x32_bf16 v[32:35], a[172:175], a[76:79], v[32:35]
    s_waitcnt lgkmcnt(0)
    v_add_f32 v56, v56, v68
    v_add_f32 v57, v57, v69
    v_mfma_f32_16x16x32_bf16 v[44:47], a[172:175], a[156:159], v[44:47]
    v_add_f32 v58, v58, v70
    v_add_f32 v59, v59, v71
    v_add_f32 v60, v60, v72
    v_mfma_f32_16x16x32_bf16 v[36:39], a[176:179], a[76:79], v[36:39]
    v_add_f32 v61, v61, v73
    v_add_f32 v62, v62, v74
    v_mfma_f32_16x16x32_bf16 v[48:51], a[176:179], a[156:159], v[48:51]
    v_add_f32 v63, v63, v75
    v_add_f32 v64, v64, v76
    v_add_f32 v65, v65, v77
    v_mfma_f32_16x16x32_bf16 v[40:43], a[180:183], a[76:79], v[40:43]
    v_add_f32 v66, v66, v78
    v_add_f32 v67, v67, v79
    ds_read_b128 v[68:71], v30 offset:1536
    v_mfma_f32_16x16x32_bf16 v[52:55], a[180:183], a[156:159], v[52:55]
    ds_read_b128 v[72:75], v30 offset:1600
    ds_read_b128 v[76:79], v30 offset:1664
    s_waitcnt vmcnt(0)
    s_mov_b32 s78, 0
L_h1p:
    v_and_b32 v28, 0xfffffff8, v16
    v_cmp_ne_u32 vcc, s76, v28
    s_cbranch_vccz L_h1ok
    s_add_u32 s78, s78, 1
    s_cmp_ge_u32 s78, 32768
    s_cbranch_scc1 L_h1ok
    buffer_load_dword v16, v17, s[40:43], s56 offen sc1
    s_waitcnt vmcnt(0)
    s_branch L_h1p
L_h1ok:
    v_cmp_ne_u32 vcc, s77, v16
    s_and_b64 vcc, vcc, s[88:89]
    s_cselect_b32 s79, 0, 1
    s_lshl_b32 s3, s27, 16
    s_add_u32 s3, s3, 7946240
    buffer_load_dwordx4 a[0:3], v9, s[40:43], s3 offen sc1
    s_add_u32 s3, s3, 4096
    buffer_load_dwordx4 a[4:7], v9, s[40:43], s3 offen sc1
    s_add_u32 s3, s3, 4096
    buffer_load_dwordx4 a[8:11], v9, s[40:43], s3 offen sc1
    s_add_u32 s3, s3, 4096
    buffer_load_dwordx4 a[12:15], v9, s[40:43], s3 offen sc1
    s_add_u32 s3, s3, 4096
    buffer_load_dwordx4 a[16:19], v9, s[40:43], s3 offen sc1
    s_add_u32 s3, s3, 4096
    buffer_load_dwordx4 a[20:23], v9, s[40:43], s3 offen sc1
    s_add_u32 s3, s3, 4096
    buffer_load_dwordx4 a[24:27], v9, s[40:43], s3 offen sc1
    s_add_u32 s3, s3, 4096
    buffer_load_dwordx4 a[28:31], v9, s[40:43], s3 offen sc1
    s_add_u32 s3, s3, 4096
    buffer_load_dwordx4 a[32:35], v9, s[40:43], s3 offen sc1
    s_add_u32 s3, s3, 4096
    buffer_load_dwordx4 a[36:39], v9, s[40:43], s3 offen sc1
    s_add_u32 s3, s3, 4096
    buffer_load_dwordx4 a[40:43], v9, s[40:43], s3 offen sc1
    s_add_u32 s3, s3, 4096
    buffer_load_dwordx4 a[44:47], v9, s[40:43], s3 offen sc1
    s_add_u32 s3, s3, 4096
    buffer_load_dwordx4 a[48:51], v9, s[40:43], s3 offen sc1
    s_add_u32 s3, s3, 4096
    buffer_load_dwordx4 a[52:55], v9, s[40:43], s3 offen sc1
    s_add_u32 s3, s3, 4096
    buffer_load_dwordx4 a[56:59], v9, s[40:43], s3 offen sc1
    s_add_u32 s3, s3, 4096
    buffer_load_dwordx4 a[60:63], v9, s[40:43], s3 offen sc1
    s_add_u32 s3, s3, 4096
    v_pk_add_f32 v[56:57], v[56:57], v[96:97]
    v_pk_add_f32 v[58:59], v[58:59], v[98:99]
    v_pk_add_f32 v[60:61], v[60:61], v[100:101]
    v_pk_add_f32 v[62:63], v[62:63], v[102:103]
    v_pk_add_f32 v[64:65], v[64:65], v[104:105]
    v_pk_add_f32 v[66:67], v[66:67], v[106:107]
    s_waitcnt lgkmcnt(0)
    v_pk_add_f32 v[56:57], v[56:57], v[68:69]
    v_pk_add_f32 v[58:59], v[58:59], v[70:71]
    v_pk_add_f32 v[60:61], v[60:61], v[72:73]
    v_pk_add_f32 v[62:63], v[62:63], v[74:75]
    v_pk_add_f32 v[64:65], v[64:65], v[76:77]
    v_pk_add_f32 v[66:67], v[66:67], v[78:79]
    v_pk_mul_f32 v[72:73], v[56:57], v[114:115] op_sel:[0,0] op_sel_hi:[1,0]
    v_pk_mul_f32 v[74:75], v[58:59], v[114:115] op_sel:[0,0] op_sel_hi:[1,0]
    v_pk_fma_f32 v[32:33], v[32:33], v[112:113], v[72:73] op_sel:[0,0,0] op_sel_hi:[1,0,1] neg_lo:[0,0,1] neg_hi:[0,0,1]
    v_pk_fma_f32 v[34:35], v[34:35], v[112:113], v[74:75] op_sel:[0,0,0] op_sel_hi:[1,0,1] neg_lo:[0,0,1] neg_hi:[0,0,1]
    v_pk_mul_f32 v[72:73], v[32:33], s[94:95]
    v_pk_mul_f32 v[74:75], v[34:35], s[94:95]
    v_max_f32 v76, 0, v32
    v_max_f32 v77, 0, v33
    v_max_f32 v78, 0, v34
    v_max_f32 v79, 0, v35
    v_exp_f32_e64 v72, v72 clamp
    v_exp_f32_e64 v73, v73 clamp
    v_exp_f32_e64 v74, v74 clamp
    v_exp_f32_e64 v75, v75 clamp
    v_pk_add_f32 v[76:77], v[76:77], s[96:97]
    v_pk_add_f32 v[78:79], v[78:79], s[96:97]
    v_pk_add_f32 v[32:33], v[72:73], v[76:77]
    v_pk_add_f32 v[34:35], v[74:75], v[78:79]
    v_cvt_pk_bf16_f32 v96, v32, v33
    v_cvt_pk_bf16_f32 v97, v34, v35
    buffer_load_dwordx4 v[220:223], v8, s[40:43], s65 offen offset:1024 sc1
    buffer_load_dwordx4 v[224:227], v8, s[40:43], s65 offen offset:2048 sc1
    v_pk_mul_f32 v[72:73], v[60:61], v[114:115] op_sel:[0,0] op_sel_hi:[1,0]
    v_pk_mul_f32 v[74:75], v[62:63], v[114:115] op_sel:[0,0] op_sel_hi:[1,0]
    v_pk_fma_f32 v[36:37], v[36:37], v[112:113], v[72:73] op_sel:[0,0,0] op_sel_hi:[1,0,1] neg_lo:[0,0,1] neg_hi:[0,0,1]
    v_pk_fma_f32 v[38:39], v[38:39], v[112:113], v[74:75] op_sel:[0,0,0] op_sel_hi:[1,0,1] neg_lo:[0,0,1] neg_hi:[0,0,1]
    v_pk_mul_f32 v[72:73], v[36:37], s[94:95]
    v_pk_mul_f32 v[74:75], v[38:39], s[94:95]
    v_max_f32 v76, 0, v36
    v_max_f32 v77, 0, v37
    v_max_f32 v78, 0, v38
    v_max_f32 v79, 0, v39
    v_exp_f32_e64 v72, v72 clamp
    v_exp_f32_e64 v73, v73 clamp
    v_exp_f32_e64 v74, v74 clamp
    v_exp_f32_e64 v75, v75 clamp
    v_pk_add_f32 v[76:77], v[76:77], s[96:97]
    v_pk_add_f32 v[78:79], v[78:79], s[96:97]
    v_pk_add_f32 v[36:37], v[72:73], v[76:77]
    v_pk_add_f32 v[38:39], v[74:75], v[78:79]
    v_cvt_pk_bf16_f32 v98, v36, v37
    v_cvt_pk_bf16_f32 v99, v38, v39
    buffer_load_dwordx4 v[228:231], v8, s[40:43], s65 offen offset:3072 sc1
    buffer_load_dwordx4 v[232:235], v12, s[40:43], s65 offen offset:0 sc1
    s_add_u32 s65, s65, 20480
    v_pk_mul_f32 v[72:73], v[64:65], v[114:115] op_sel:[0,0] op_sel_hi:[1,0]
    v_pk_mul_f32 v[74:75], v[66:67], v[114:115] op_sel:[0,0] op_sel_hi:[1,0]
    v_pk_fma_f32 v[40:41], v[40:41], v[112:113], v[72:73] op_sel:[0,0,0] op_sel_hi:[1,0,1] neg_lo:[0,0,1] neg_hi:[0,0,1]
    v_pk_fma_f32 v[42:43], v[42:43], v[112:113], v[74:75] op_sel:[0,0,0] op_sel_hi:[1,0,1] neg_lo:[0,0,1] neg_hi:[0,0,1]
    v_pk_mul_f32 v[72:73], v[40:41], s[94:95]
    v_pk_mul_f32 v[74:75], v[42:43], s[94:95]
    v_max_f32 v76, 0, v40
    v_max_f32 v77, 0, v41
    v_max_f32 v78, 0, v42
    v_max_f32 v79, 0, v43
    v_exp_f32_e64 v72, v72 clamp
    v_exp_f32_e64 v73, v73 clamp
    v_exp_f32_e64 v74, v74 clamp
    v_exp_f32_e64 v75, v75 clamp
    v_pk_add_f32 v[76:77], v[76:77], s[96:97]
    v_pk_add_f32 v[78:79], v[78:79], s[96:97]
    v_pk_add_f32 v[40:41], v[72:73], v[76:77]
    v_pk_add_f32 v[42:43], v[74:75], v[78:79]
    v_cvt_pk_bf16_f32 v100, v40, v41
    v_cndmask_b32 v100, 0, v100, s[90:91]
    v_cvt_pk_bf16_f32 v101, v42, v43
    v_cndmask_b32 v101, 0, v101, s[90:91]
    buffer_load_dwordx4 v[236:239], v8, s[40:43], s65 offen offset:0 sc1
    buffer_load_dwordx4 v[240:243], v8, s[40:43], s65 offen offset:1024 sc1
    v_pk_mul_f32 v[72:73], v[56:57], v[114:115] op_sel:[0,1] op_sel_hi:[1,1]
    v_pk_mul_f32 v[74:75], v[58:59], v[114:115] op_sel:[0,1] op_sel_hi:[1,1]
    v_pk_fma_f32 v[44:45], v[44:45], v[112:113], v[72:73] op_sel:[0,1,0] op_sel_hi:[1,1,1] neg_lo:[0,0,1] neg_hi:[0,0,1]
    v_pk_fma_f32 v[46:47], v[46:47], v[112:113], v[74:75] op_sel:[0,1,0] op_sel_hi:[1,1,1] neg_lo:[0,0,1] neg_hi:[0,0,1]
    v_pk_mul_f32 v[72:73], v[44:45], s[94:95]
    v_pk_mul_f32 v[74:75], v[46:47], s[94:95]
    v_max_f32 v76, 0, v44
    v_max_f32 v77, 0, v45
    v_max_f32 v78, 0, v46
    v_max_f32 v79, 0, v47
    v_exp_f32_e64 v72, v72 clamp
    v_exp_f32_e64 v73, v73 clamp
    v_exp_f32_e64 v74, v74 clamp
    v_exp_f32_e64 v75, v75 clamp
    v_pk_add_f32 v[76:77], v[76:77], s[96:97]
    v_pk_add_f32 v[78:79], v[78:79], s[96:97]
    v_pk_add_f32 v[44:45], v[72:73], v[76:77]
    v_pk_add_f32 v[46:47], v[74:75], v[78:79]
    v_cvt_pk_bf16_f32 v102, v44, v45
    v_cvt_pk_bf16_f32 v103, v46, v47
    buffer_load_dwordx4 v[244:247], v8, s[40:43], s65 offen offset:2048 sc1
    buffer_load_dwordx4 v[248:251], v8, s[40:43], s65 offen offset:3072 sc1
    v_pk_mul_f32 v[72:73], v[60:61], v[114:115] op_sel:[0,1] op_sel_hi:[1,1]
    v_pk_mul_f32 v[74:75], v[62:63], v[114:115] op_sel:[0,1] op_sel_hi:[1,1]
    v_pk_fma_f32 v[48:49], v[48:49], v[112:113], v[72:73] op_sel:[0,1,0] op_sel_hi:[1,1,1] neg_lo:[0,0,1] neg_hi:[0,0,1]
    v_pk_fma_f32 v[50:51], v[50:51], v[112:113], v[74:75] op_sel:[0,1,0] op_sel_hi:[1,1,1] neg_lo:[0,0,1] neg_hi:[0,0,1]
    v_pk_mul_f32 v[72:73], v[48:49], s[94:95]
    v_pk_mul_f32 v[74:75], v[50:51], s[94:95]
    v_max_f32 v76, 0, v48
    v_max_f32 v77, 0, v49
    v_max_f32 v78, 0, v50
    v_max_f32 v79, 0, v51
    v_exp_f32_e64 v72, v72 clamp
    v_exp_f32_e64 v73, v73 clamp
    v_exp_f32_e64 v74, v74 clamp
    v_exp_f32_e64 v75, v75 clamp
    v_pk_add_f32 v[76:77], v[76:77], s[96:97]
    v_pk_add_f32 v[78:79], v[78:79], s[96:97]
    v_pk_add_f32 v[48:49], v[72:73], v[76:77]
    v_pk_add_f32 v[50:51], v[74:75], v[78:79]
    v_cvt_pk_bf16_f32 v104, v48, v49
    v_cvt_pk_bf16_f32 v105, v50, v51
    buffer_load_dwordx4 v[252:255], v12, s[40:43], s65 offen offset:0 sc1
    s_add_u32 s65, s65, 20480
    buffer_load_dwordx4 v[116:119], v14, s[32:35], s51 offen
    v_pk_mul_f32 v[72:73], v[64:65], v[114:115] op_sel:[0,1] op_sel_hi:[1,1]
    v_pk_mul_f32 v[74:75], v[66:67], v[114:115] op_sel:[0,1] op_sel_hi:[1,1]
    v_pk_fma_f32 v[52:53], v[52:53], v[112:113], v[72:73] op_sel:[0,1,0] op_sel_hi:[1,1,1] neg_lo:[0,0,1] neg_hi:[0,0,1]
    v_pk_fma_f32 v[54:55], v[54:55], v[112:113], v[74:75] op_sel:[0,1,0] op_sel_hi:[1,1,1] neg_lo:[0,0,1] neg_hi:[0,0,1]
    v_pk_mul_f32 v[72:73], v[52:53], s[94:95]
    v_pk_mul_f32 v[74:75], v[54:55], s[94:95]
    v_max_f32 v76, 0, v52
    v_max_f32 v77, 0, v53
    v_max_f32 v78, 0, v54
    v_max_f32 v79, 0, v55
    v_exp_f32_e64 v72, v72 clamp
    v_exp_f32_e64 v73, v73 clamp
    v_exp_f32_e64 v74, v74 clamp
    v_exp_f32_e64 v75, v75 clamp
    v_pk_add_f32 v[76:77], v[76:77], s[96:97]
    v_pk_add_f32 v[78:79], v[78:79], s[96:97]
    v_pk_add_f32 v[52:53], v[72:73], v[76:77]
    v_pk_add_f32 v[54:55], v[74:75], v[78:79]
    v_cvt_pk_bf16_f32 v106, v52, v53
    v_cndmask_b32 v106, 0, v106, s[90:91]
    v_cvt_pk_bf16_f32 v107, v54, v55
    v_cndmask_b32 v107, 0, v107, s[90:91]
    buffer_load_dwordx4 v[120:123], v14, s[32:35], s51 offen offset:64
    buffer_load_dwordx2 v[124:125], v15, s[32:35], s51 offen offset:128
    v_and_b32 v56, 0xffff, v146
    v_add_u32 v56, 153600, v56
    v_lshrrev_b32 v57, 16, v146
    v_add_u32 v57, 153600, v57
    v_and_b32 v58, 0xffff, v147
    v_add_u32 v58, 153600, v58
    v_lshrrev_b32 v59, 16, v147
    v_add_u32 v59, 153600, v59
    v_and_b32 v60, 0xffff, v148
    v_add_u32 v60, 153600, v60
    v_lshrrev_b32 v61, 16, v148
    v_add_u32 v61, 153600, v61
    v_and_b32 v62, 0xffff, v149
    v_add_u32 v62, 153600, v62
    v_lshrrev_b32 v63, 16, v149
    v_add_u32 v63, 153600, v63
    v_and_b32 v64, 0xffff, v150
    v_add_u32 v64, 153600, v64
    v_lshrrev_b32 v65, 16, v150
    v_add_u32 v65, 153600, v65
    v_and_b32 v66, 0xffff, v151
    v_add_u32 v66, 153600, v66
    v_lshrrev_b32 v67, 16, v151
    v_add_u32 v67, 153600, v67
    s_waitcnt vmcnt(24)
    v_accvgpr_read_b32 v32, a0
    v_accvgpr_read_b32 v33, a1
    v_accvgpr_read_b32 v34, a2
    v_accvgpr_read_b32 v35, a3
    v_accvgpr_read_b32 v36, a4
    v_accvgpr_read_b32 v37, a5
    v_accvgpr_read_b32 v38, a6
    v_accvgpr_read_b32 v39, a7
    v_pk_add_f32 v[32:33], v[32:33], v[36:37]
    v_pk_add_f32 v[34:35], v[34:35], v[38:39]
    v_accvgpr_read_b32 v36, a8
    v_accvgpr_read_b32 v37, a9
    v_accvgpr_read_b32 v38, a10
    v_accvgpr_read_b32 v39, a11
    v_pk_add_f32 v[32:33], v[32:33], v[36:37]
    v_pk_add_f32 v[34:35], v[34:35], v[38:39]
    v_accvgpr_read_b32 v36, a12
    v_accvgpr_read_b32 v37, a13
    v_accvgpr_read_b32 v38, a14
    v_accvgpr_read_b32 v39, a15
    v_pk_add_f32 v[32:33], v[32:33], v[36:37]
    v_pk_add_f32 v[34:35], v[34:35], v[38:39]
    v_lshlrev_b32 v31, 3, v11
    s_lshl_b32 s98, s53, 5
    buffer_load_dwordx4 a[204:207], v23, s[36:39], s98 offen offset:0
    buffer_load_dwordx4 a[208:211], v23, s[36:39], s98 offen offset:64
    buffer_load_dwordx4 a[212:215], v23, s[36:39], s98 offen offset:128
    buffer_load_dwordx2 a[216:217], v31, s[36:39], s98 offen offset:192
    s_mul_i32 s98, s27, 20
    s_mul_i32 s99, s28, 5
    s_add_u32 s98, s98, s99
    s_lshl_b32 s98, s98, 9
    s_add_u32 s98, s98, 5324800
    s_mov_b64 exec, s[66:67]
    buffer_load_dwordx4 v[126:129], v26, s[40:43], s98 offen offset:0 sc1
    buffer_load_dwordx4 v[130:133], v26, s[40:43], s98 offen offset:512 sc1
    buffer_load_dwordx4 v[134:137], v26, s[40:43], s98 offen offset:1024 sc1
    buffer_load_dwordx4 v[138:141], v26, s[40:43], s98 offen offset:1536 sc1
    buffer_load_dwordx4 v[142:145], v26, s[40:43], s98 offen offset:2048 sc1
    s_mov_b64 exec, -1
    s_waitcnt vmcnt(29)
    v_accvgpr_read_b32 v36, a16
    v_accvgpr_read_b32 v37, a17
    v_accvgpr_read_b32 v38, a18
    v_accvgpr_read_b32 v39, a19
    v_pk_add_f32 v[32:33], v[32:33], v[36:37]
    v_pk_add_f32 v[34:35], v[34:35], v[38:39]
    v_accvgpr_read_b32 v36, a20
    v_accvgpr_read_b32 v37, a21
    v_accvgpr_read_b32 v38, a22
    v_accvgpr_read_b32 v39, a23
    v_pk_add_f32 v[32:33], v[32:33], v[36:37]
    v_pk_add_f32 v[34:35], v[34:35], v[38:39]
    v_accvgpr_read_b32 v36, a24
    v_accvgpr_read_b32 v37, a25
    v_accvgpr_read_b32 v38, a26
    v_accvgpr_read_b32 v39, a27
    v_pk_add_f32 v[32:33], v[32:33], v[36:37]
    v_pk_add_f32 v[34:35], v[34:35], v[38:39]
    v_accvgpr_read_b32 v36, a28
    v_accvgpr_read_b32 v37, a29
    v_accvgpr_read_b32 v38, a30
    v_accvgpr_read_b32 v39, a31
    v_pk_add_f32 v[32:33], v[32:33], v[36:37]
    v_pk_add_f32 v[34:35], v[34:35], v[38:39]
    s_mul_i32 s98, s28, 24576
    s_add_u32 m0, s98, 0
    s_add_u32 s98, s55, m0
    buffer_load_dwordx4 v8, s[40:43], s98 offen sc1 lds
    s_mul_i32 s98, s28, 24576
    s_add_u32 m0, s98, 1024
    s_add_u32 s98, s55, m0
    buffer_load_dwordx4 v8, s[40:43], s98 offen sc1 lds
    s_waitcnt vmcnt(27)
    v_accvgpr_read_b32 v36, a32
    v_accvgpr_read_b32 v37, a33
    v_accvgpr_read_b32 v38, a34
    v_accvgpr_read_b32 v39, a35
    v_pk_add_f32 v[32:33], v[32:33], v[36:37]
    v_pk_add_f32 v[34:35], v[34:35], v[38:39]
    v_accvgpr_read_b32 v36, a36
    v_accvgpr_read_b32 v37, a37
    v_accvgpr_read_b32 v38, a38
    v_accvgpr_read_b32 v39, a39
    v_pk_add_f32 v[32:33], v[32:33], v[36:37]
    v_pk_add_f32 v[34:35], v[34:35], v[38:39]
    v_accvgpr_read_b32 v36, a40
    v_accvgpr_read_b32 v37, a41
    v_accvgpr_read_b32 v38, a42
    v_accvgpr_read_b32 v39, a43
    v_pk_add_f32 v[32:33], v[32:33], v[36:37]
    v_pk_add_f32 v[34:35], v[34:35], v[38:39]
    v_accvgpr_read_b32 v36, a44
    v_accvgpr_read_b32 v37, a45
    v_accvgpr_read_b32 v38, a46
    v_accvgpr_read_b32 v39, a47
    v_pk_add_f32 v[32:33], v[32:33], v[36:37]
    v_pk_add_f32 v[34:35], v[34:35], v[38:39]
    s_mul_i32 s98, s28, 24576
    s_add_u32 m0, s98, 2048
    s_add_u32 s98, s55, m0
    buffer_load_dwordx4 v8, s[40:43], s98 offen sc1 lds
    s_mul_i32 s98, s28, 24576
    s_add_u32 m0, s98, 3072
    s_add_u32 s98, s55, m0
    buffer_load_dwordx4 v8, s[40:43], s98 offen sc1 lds
    s_waitcnt vmcnt(25)
    v_accvgpr_read_b32 v36, a48
    v_accvgpr_read_b32 v37, a49
    v_accvgpr_read_b32 v38, a50
    v_accvgpr_read_b32 v39, a51
    v_pk_add_f32 v[32:33], v[32:33], v[36:37]
    v_pk_add_f32 v[34:35], v[34:35], v[38:39]
    v_accvgpr_read_b32 v36, a52
    v_accvgpr_read_b32 v37, a53
    v_accvgpr_read_b32 v38, a54
    v_accvgpr_read_b32 v39, a55
    v_pk_add_f32 v[32:33], v[32:33], v[36:37]
    v_pk_add_f32 v[34:35], v[34:35], v[38:39]
    v_accvgpr_read_b32 v36, a56
    v_accvgpr_read_b32 v37, a57
    v_accvgpr_read_b32 v38, a58
    v_accvgpr_read_b32 v39, a59
    v_pk_add_f32 v[32:33], v[32:33], v[36:37]
    v_pk_add_f32 v[34:35], v[34:35], v[38:39]
    v_accvgpr_read_b32 v36, a60
    v_accvgpr_read_b32 v37, a61
    v_accvgpr_read_b32 v38, a62
    v_accvgpr_read_b32 v39, a63
    v_pk_add_f32 v[32:33], v[32:33], v[36:37]
    v_pk_add_f32 v[34:35], v[34:35], v[38:39]
    s_mul_i32 s98, s28, 24576
    s_add_u32 m0, s98, 4096
    s_add_u32 s98, s55, m0
    buffer_load_dwordx4 v8, s[40:43], s98 offen sc1 lds
    s_mul_i32 s98, s28, 24576
    s_add_u32 m0, s98, 5120
    s_add_u32 s98, s55, m0
    buffer_load_dwordx4 v8, s[40:43], s98 offen sc1 lds
    v_cvt_pk_bf16_f32 v18, v32, v33
    v_cvt_pk_bf16_f32 v19, v34, v35
    v_cmp_gt_u32 vcc, 210, v0
    s_nop 1
    v_cndmask_b32 v18, 0, v18, vcc
    v_cndmask_b32 v19, 0, v19, vcc
    v_lshlrev_b32 v27, 3, v0
    v_add_u32 v27, 153600, v27
    ds_write_b64 v27, v[18:19]
    s_waitcnt lgkmcnt(0)
    s_barrier
    ds_read_b64 a[64:65], v56
    ds_read_b64 a[66:67], v57
    ds_read_b64 a[68:69], v58
    ds_read_b64 a[72:73], v59
    ds_read_b64 a[74:75], v60
    ds_read_b64 a[76:77], v61
    ds_read_b64 a[80:81], v62
    ds_read_b64 a[82:83], v63
    ds_read_b64 a[84:85], v64
    ds_read_b64 a[88:89], v65
    ds_read_b64 a[90:91], v66
    ds_read_b64 a[92:93], v67
    s_mul_i32 s3, s28, 40960
    s_mul_i32 s56, s27, 1280
    s_add_u32 s3, s3, s56
    s_add_u32 s3, s3, s58
    v_lshlrev_b32 v27, 2, v10
    v_lshl_add_u32 v27, v11, 3, v27
    v_cndmask_b32 v27, v2, v27, s[90:91]
    s_waitcnt lgkmcnt(0)
    v_mfma_f32_16x16x32_bf16 v[44:47], a[88:91], v[96:99], 0
    v_mfma_f32_16x16x32_bf16 v[32:35], a[64:67], v[96:99], 0
    v_mfma_f32_16x16x32_bf16 v[36:39], a[72:75], v[96:99], 0
    v_mfma_f32_16x16x32_bf16 v[40:43], a[80:83], v[96:99], 0
    v_mfma_f32_16x16x32_bf16 v[60:63], a[88:91], v[102:105], 0
    v_mfma_f32_16x16x32_bf16 v[48:51], a[64:67], v[102:105], 0
    v_mfma_f32_16x16x32_bf16 v[52:55], a[72:75], v[102:105], 0
    v_mfma_f32_16x16x32_bf16 v[56:59], a[80:83], v[102:105], 0
    v_mfma_f32_16x16x16_bf16 v[44:47], a[92:93], v[100:101], v[44:47]
    v_mfma_f32_16x16x16_bf16 v[32:35], a[68:69], v[100:101], v[32:35]
    v_mfma_f32_16x16x16_bf16 v[36:39], a[76:77], v[100:101], v[36:39]
    v_mfma_f32_16x16x16_bf16 v[40:43], a[84:85], v[100:101], v[40:43]
    v_mfma_f32_16x16x16_bf16 v[60:63], a[92:93], v[106:107], v[60:63]
    v_mfma_f32_16x16x16_bf16 v[48:51], a[68:69], v[106:107], v[48:51]
    v_mfma_f32_16x16x16_bf16 v[52:55], a[76:77], v[106:107], v[52:55]
    v_mfma_f32_16x16x16_bf16 v[56:59], a[84:85], v[106:107], v[56:59]
    s_nop 0
    v_add_f32 v20, s61, v44
    v_add_f32 v21, s61, v45
    v_rcp_f32 v20, v20
    v_rcp_f32 v21, v21
    s_nop 0
    v_cndmask_b32 v22, v21, v20, s[92:93]
    v_cndmask_b32 v28, v21, v20, s[90:91]
    v_mul_f32 v32, v32, v22
    v_mul_f32 v33, v33, v22
    v_mul_f32 v34, v34, v22
    v_mul_f32 v35, v35, v22
    v_cvt_pk_bf16_f32 v64, v32, v33
    v_cvt_pk_bf16_f32 v65, v34, v35
    v_mul_f32 v36, v36, v28
    v_mul_f32 v37, v37, v28
    v_mul_f32 v38, v38, v28
    v_mul_f32 v39, v39, v28
    v_cvt_pk_bf16_f32 v66, v36, v37
    v_cvt_pk_bf16_f32 v67, v38, v39
    v_mul_f32 v40, v40, v21
    v_mul_f32 v41, v41, v21
    v_mul_f32 v42, v42, v21
    v_mul_f32 v43, v43, v21
    v_cvt_pk_bf16_f32 v68, v40, v41
    v_cvt_pk_bf16_f32 v69, v42, v43
    buffer_store_dwordx4 v[64:67], v8, s[40:43], s3 offen sc1
    buffer_store_dwordx2 v[68:69], v27, s[40:43], s3 offen offset:1024 sc1
    s_add_u32 s3, s3, 20480
    v_add_f32 v20, s61, v60
    v_add_f32 v21, s61, v61
    v_rcp_f32 v20, v20
    v_rcp_f32 v21, v21
    s_nop 0
    v_cndmask_b32 v22, v21, v20, s[92:93]
    v_cndmask_b32 v28, v21, v20, s[90:91]
    v_mul_f32 v48, v48, v22
    v_mul_f32 v49, v49, v22
    v_mul_f32 v50, v50, v22
    v_mul_f32 v51, v51, v22
    v_cvt_pk_bf16_f32 v72, v48, v49
    v_cvt_pk_bf16_f32 v73, v50, v51
    v_mul_f32 v52, v52, v28
    v_mul_f32 v53, v53, v28
    v_mul_f32 v54, v54, v28
    v_mul_f32 v55, v55, v28
    v_cvt_pk_bf16_f32 v74, v52, v53
    v_cvt_pk_bf16_f32 v75, v54, v55
    v_mul_f32 v56, v56, v21
    v_mul_f32 v57, v57, v21
    v_mul_f32 v58, v58, v21
    v_mul_f32 v59, v59, v21
    v_cvt_pk_bf16_f32 v76, v56, v57
    v_cvt_pk_bf16_f32 v77, v58, v59
    buffer_store_dwordx4 v[72:75], v8, s[40:43], s3 offen sc1
    buffer_store_dwordx2 v[76:77], v27, s[40:43], s3 offen offset:1024 sc1
    s_add_u32 s3, s3, 20480
    s_add_u32 s3, s28, 0
    s_and_b32 s3, s3, 3
    s_lshl_b32 s57, s48, 2
    s_add_u32 s3, s3, s57
    s_mul_i32 s3, s3, 20
    s_add_u32 s3, s3, s28
    s_lshl_b32 s3, s3, 10
    s_add_u32 s3, s3, s58
    s_add_u32 s80, s3, 0
    s_add_u32 s3, s28, 1
    s_and_b32 s3, s3, 3
    s_lshl_b32 s57, s48, 2
    s_add_u32 s3, s3, s57
    s_mul_i32 s3, s3, 20
    s_add_u32 s3, s3, s28
    s_lshl_b32 s3, s3, 10
    s_add_u32 s3, s3, s58
    s_add_u32 s81, s3, 0
    s_add_u32 s3, s28, 2
    s_and_b32 s3, s3, 3
    s_lshl_b32 s57, s48, 2
    s_add_u32 s3, s3, s57
    s_mul_i32 s3, s3, 20
    s_add_u32 s3, s3, s28
    s_lshl_b32 s3, s3, 10
    s_add_u32 s3, s3, s58
    s_add_u32 s82, s3, 0
    s_add_u32 s3, s28, 3
    s_and_b32 s3, s3, 3
    s_lshl_b32 s57, s48, 2
    s_add_u32 s3, s3, s57
    s_mul_i32 s3, s3, 20
    s_add_u32 s3, s3, s28
    s_lshl_b32 s3, s3, 10
    s_add_u32 s3, s3, s58
    s_add_u32 s83, s3, 0
    s_mul_i32 s99, s28, 40960
    s_mul_i32 s56, s27, 1280
    s_add_u32 s99, s99, s56
    s_add_u32 s99, s99, s58
    v_mul_u32_u24 v28, 20480, v11
    v_lshl_add_u32 v28, v10, 5, v28
    s_add_u32 s59, s58, 335872
    s_lshl_b32 s3, s27, 2
    s_add_u32 s3, s3, s59
    s_waitcnt vmcnt(0)
    s_barrier
    s_cmp_lg_u32 s28, 0
    s_cbranch_scc1 L_g0np
    s_mov_b64 exec, 1
    s_cmp_eq_u32 s79, 0
    s_cbranch_scc1 L_g0slow
    buffer_store_dword v6, v5, s[40:43], s3 offen
    s_branch L_g0pd
L_g0slow:
    buffer_store_dword v6, v5, s[40:43], s3 offen sc1
L_g0pd:
    s_mov_b64 exec, -1
L_g0np:
    s_lshl_b32 s98, s27, 2
    s_add_u32 s98, s98, s28
    s_mul_i32 s98, s98, 256
    s_add_u32 s98, s98, L_cS4-L_pc
    v_add_u32 v31, s98, v3
    s_bfm_b64 exec, 2, 0
    global_load_dword v4, v31, s[30:31]
    s_mov_b64 exec, -1
    s_mul_i32 s98, s28, 24576
    s_add_u32 m0, s98, 6144
    s_add_u32 s98, s55, m0
    buffer_load_dwordx4 v8, s[40:43], s98 offen sc1 lds
    s_mul_i32 s98, s28, 24576
    s_add_u32 m0, s98, 7168
    s_add_u32 s98, s55, m0
    buffer_load_dwordx4 v8, s[40:43], s98 offen sc1 lds
    s_mul_i32 s98, s28, 24576
    s_add_u32 m0, s98, 8192
    s_add_u32 s98, s55, m0
    buffer_load_dwordx4 v8, s[40:43], s98 offen sc1 lds
    s_mul_i32 s98, s28, 24576
    s_add_u32 m0, s98, 9216
    s_add_u32 s98, s55, m0
    buffer_load_dwordx4 v8, s[40:43], s98 offen sc1 lds
    s_mul_i32 s98, s28, 24576
    s_add_u32 m0, s98, 10240
    s_add_u32 s98, s55, m0
    buffer_load_dwordx4 v8, s[40:43], s98 offen sc1 lds
    s_mul_i32 s98, s28, 24576
    s_add_u32 m0, s98, 11264
    s_add_u32 s98, s55, m0
    buffer_load_dwordx4 v8, s[40:43], s98 offen sc1 lds
    s_mul_i32 s98, s28, 24576
    s_add_u32 m0, s98, 12288
    s_add_u32 s98, s55, m0
    buffer_load_dwordx4 v8, s[40:43], s98 offen sc1 lds
    s_mul_i32 s98, s28, 24576
    s_add_u32 m0, s98, 13312
    s_add_u32 s98, s55, m0
    buffer_load_dwordx4 v8, s[40:43], s98 offen sc1 lds
    s_mul_i32 s98, s28, 24576
    s_add_u32 m0, s98, 14336
    s_add_u32 s98, s55, m0
    buffer_load_dwordx4 v8, s[40:43], s98 offen sc1 lds
    s_cmp_lg_u32 s28, 0
    s_cbranch_scc1 L_g0j
    s_mov_b32 s78, 0
L_g0p:
    buffer_load_dword v27, v10, s[40:43], s59 offen sc1
    s_add_u32 s78, s78, 1
    s_waitcnt vmcnt(0)
    v_cmp_ne_u32 vcc, s76, v27
    s_cmp_ge_u32 s78, 32768
    s_cbranch_scc1 L_g0x
    s_cbranch_vccnz L_g0p
L_g0x:
L_g0j:
    s_barrier
    buffer_load_dwordx4 a[0:3], v8, s[40:43], s80 offen sc1
    s_add_u32 s80, s80, 4096
    buffer_load_dwordx4 a[4:7], v8, s[40:43], s81 offen sc1
    s_add_u32 s81, s81, 4096
    buffer_load_dwordx4 a[8:11], v8, s[40:43], s82 offen sc1
    s_add_u32 s82, s82, 4096
    buffer_load_dwordx4 a[12:15], v8, s[40:43], s83 offen sc1
    s_add_u32 s83, s83, 4096
    buffer_load_dwordx4 a[16:19], v8, s[40:43], s80 offen sc1
    s_add_u32 s80, s80, 4096
    buffer_load_dwordx4 a[20:23], v8, s[40:43], s81 offen sc1
    s_add_u32 s81, s81, 4096
    buffer_load_dwordx4 a[24:27], v8, s[40:43], s82 offen sc1
    s_add_u32 s82, s82, 4096
    buffer_load_dwordx4 a[28:31], v8, s[40:43], s83 offen sc1
    s_add_u32 s83, s83, 4096
    buffer_load_dwordx4 a[32:35], v8, s[40:43], s80 offen sc1
    s_add_u32 s80, s80, 4096
    buffer_load_dwordx4 a[36:39], v8, s[40:43], s81 offen sc1
    s_add_u32 s81, s81, 4096
    buffer_load_dwordx4 a[40:43], v8, s[40:43], s82 offen sc1
    s_add_u32 s82, s82, 4096
    buffer_load_dwordx4 a[44:47], v8, s[40:43], s83 offen sc1
    s_add_u32 s83, s83, 4096
    buffer_load_dwordx4 a[48:51], v8, s[40:43], s80 offen sc1
    s_add_u32 s80, s80, 4096
    buffer_load_dwordx4 a[52:55], v8, s[40:43], s81 offen sc1
    s_add_u32 s81, s81, 4096
    buffer_load_dwordx4 a[56:59], v8, s[40:43], s82 offen sc1
    s_add_u32 s82, s82, 4096
    buffer_load_dwordx4 a[60:63], v8, s[40:43], s83 offen sc1
    s_add_u32 s83, s83, 4096
    buffer_load_dwordx4 a[64:67], v8, s[40:43], s80 offen sc1
    s_add_u32 s80, s80, 4096
    buffer_load_dwordx4 a[68:71], v8, s[40:43], s81 offen sc1
    s_add_u32 s81, s81, 4096
    buffer_load_dwordx4 a[72:75], v8, s[40:43], s82 offen sc1
    s_add_u32 s82, s82, 4096
    buffer_load_dwordx4 a[76:79], v8, s[40:43], s83 offen sc1
    s_add_u32 s83, s83, 4096
    s_add_u32 s3, s28, 1
    s_and_b32 s3, s3, 3
    s_mul_i32 s3, s3, 15360
    s_add_u32 s3, s3, 102400
    v_add_u32 v17, s3, v8
    s_add_u32 s3, s28, 2
    s_and_b32 s3, s3, 3
    s_mul_i32 s3, s3, 15360
    s_add_u32 s3, s3, 102400
    v_add_u32 v18, s3, v8
    s_add_u32 s3, s28, 3
    s_and_b32 s3, s3, 3
    s_mul_i32 s3, s3, 15360
    s_add_u32 s3, s3, 102400
    v_add_u32 v19, s3, v8
    s_mul_i32 s3, s28, 15360
    s_add_u32 s3, s3, 102400
    v_add_u32 v16, s3, v8
    s_waitcnt vmcnt(49)
    v_lshlrev_b32 v32, 16, v116
    v_and_b32 v33, 0xffff0000, v116
    v_lshlrev_b32 v34, 16, v117
    v_and_b32 v35, 0xffff0000, v117
    v_lshlrev_b32 v36, 16, v118
    v_and_b32 v37, 0xffff0000, v118
    v_lshlrev_b32 v38, 16, v119
    v_and_b32 v39, 0xffff0000, v119
    v_lshlrev_b32 v40, 16, v120
    v_and_b32 v41, 0xffff0000, v120
    v_lshlrev_b32 v42, 16, v121
    v_and_b32 v43, 0xffff0000, v121
    v_lshlrev_b32 v44, 16, v122
    v_and_b32 v45, 0xffff0000, v122
    v_lshlrev_b32 v46, 16, v123
    v_and_b32 v47, 0xffff0000, v123
    v_lshlrev_b32 v48, 16, v124
    v_and_b32 v49, 0xffff0000, v124
    v_lshlrev_b32 v50, 16, v125
    v_and_b32 v51, 0xffff0000, v125
    s_waitcnt vmcnt(16)
    v_mfma_f32_16x16x32_bf16 v[32:35], v[156:159], a[0:3], v[32:35]
    s_mul_i32 s98, s28, 24576
    s_add_u32 m0, s98, 15360
    s_add_u32 s98, s55, m0
    buffer_load_dwordx4 v8, s[40:43], s98 offen sc1 lds
    v_mfma_f32_16x16x32_bf16 v[36:39], v[160:163], a[0:3], v[36:39]
    v_mfma_f32_16x16x32_bf16 v[40:43], v[164:167], a[0:3], v[40:43]
    v_mfma_f32_16x16x32_bf16 v[44:47], v[168:171], a[0:3], v[44:47]
    v_mfma_f32_16x16x32_bf16 v[48:51], v[172:175], a[0:3], v[48:51]
    v_mfma_f32_16x16x32_bf16 v[52:55], v[156:159], a[4:7], 0
    v_mfma_f32_16x16x32_bf16 v[56:59], v[160:163], a[4:7], 0
    s_mul_i32 s98, s28, 24576
    s_add_u32 m0, s98, 16384
    s_add_u32 s98, s55, m0
    buffer_load_dwordx4 v8, s[40:43], s98 offen sc1 lds
    v_mfma_f32_16x16x32_bf16 v[60:63], v[164:167], a[4:7], 0
    v_mfma_f32_16x16x32_bf16 v[64:67], v[168:171], a[4:7], 0
    v_mfma_f32_16x16x32_bf16 v[68:71], v[172:175], a[4:7], 0
    v_mfma_f32_16x16x32_bf16 v[72:75], v[156:159], a[8:11], 0
    v_mfma_f32_16x16x32_bf16 v[76:79], v[160:163], a[8:11], 0
    v_mfma_f32_16x16x32_bf16 v[80:83], v[164:167], a[8:11], 0
    v_mfma_f32_16x16x32_bf16 v[84:87], v[168:171], a[8:11], 0
    s_mul_i32 s98, s28, 24576
    s_add_u32 m0, s98, 17408
    s_add_u32 s98, s55, m0
    buffer_load_dwordx4 v8, s[40:43], s98 offen sc1 lds
    v_mfma_f32_16x16x32_bf16 v[88:91], v[172:175], a[8:11], 0
    v_mfma_f32_16x16x32_bf16 v[92:95], v[156:159], a[12:15], 0
    v_mfma_f32_16x16x32_bf16 v[96:99], v[160:163], a[12:15], 0
    v_mfma_f32_16x16x32_bf16 v[100:103], v[164:167], a[12:15], 0
    v_mfma_f32_16x16x32_bf16 v[104:107], v[168:171], a[12:15], 0
    v_mfma_f32_16x16x32_bf16 v[108:111], v[172:175], a[12:15], 0
    s_waitcnt vmcnt(15)
    v_mfma_f32_16x16x32_bf16 v[32:35], v[176:179], a[16:19], v[32:35]
    s_mul_i32 s98, s28, 24576
    s_add_u32 m0, s98, 18432
    s_add_u32 s98, s55, m0
    buffer_load_dwordx4 v8, s[40:43], s98 offen sc1 lds
    v_mfma_f32_16x16x32_bf16 v[36:39], v[180:183], a[16:19], v[36:39]
    v_mfma_f32_16x16x32_bf16 v[40:43], v[184:187], a[16:19], v[40:43]
    v_mfma_f32_16x16x32_bf16 v[44:47], v[188:191], a[16:19], v[44:47]
    v_mfma_f32_16x16x32_bf16 v[48:51], v[192:195], a[16:19], v[48:51]
    v_mfma_f32_16x16x32_bf16 v[52:55], v[176:179], a[20:23], v[52:55]
    v_mfma_f32_16x16x32_bf16 v[56:59], v[180:183], a[20:23], v[56:59]
    s_mul_i32 s98, s28, 24576
    s_add_u32 m0, s98, 19456
    s_add_u32 s98, s55, m0
    buffer_load_dwordx4 v8, s[40:43], s98 offen sc1 lds
    v_mfma_f32_16x16x32_bf16 v[60:63], v[184:187], a[20:23], v[60:63]
    v_mfma_f32_16x16x32_bf16 v[64:67], v[188:191], a[20:23], v[64:67]
    v_mfma_f32_16x16x32_bf16 v[68:71], v[192:195], a[20:23], v[68:71]
    v_mfma_f32_16x16x32_bf16 v[72:75], v[176:179], a[24:27], v[72:75]
    v_mfma_f32_16x16x32_bf16 v[76:79], v[180:183], a[24:27], v[76:79]
    v_mfma_f32_16x16x32_bf16 v[80:83], v[184:187], a[24:27], v[80:83]
    v_mfma_f32_16x16x32_bf16 v[84:87], v[188:191], a[24:27], v[84:87]
    s_mul_i32 s98, s28, 24576
    s_add_u32 m0, s98, 20480
    s_add_u32 s98, s55, m0
    buffer_load_dwordx4 v8, s[40:43], s98 offen sc1 lds
    v_mfma_f32_16x16x32_bf16 v[88:91], v[192:195], a[24:27], v[88:91]
    v_mfma_f32_16x16x32_bf16 v[92:95], v[176:179], a[28:31], v[92:95]
    v_mfma_f32_16x16x32_bf16 v[96:99], v[180:183], a[28:31], v[96:99]
    v_mfma_f32_16x16x32_bf16 v[100:103], v[184:187], a[28:31], v[100:103]
    v_mfma_f32_16x16x32_bf16 v[104:107], v[188:191], a[28:31], v[104:107]
    v_mfma_f32_16x16x32_bf16 v[108:111], v[192:195], a[28:31], v[108:111]
    s_waitcnt vmcnt(14)
    v_mfma_f32_16x16x32_bf16 v[32:35], v[196:199], a[32:35], v[32:35]
    s_mul_i32 s98, s28, 24576
    s_add_u32 m0, s98, 21504
    s_add_u32 s98, s55, m0
    buffer_load_dwordx4 v8, s[40:43], s98 offen sc1 lds
    v_mfma_f32_16x16x32_bf16 v[36:39], v[200:203], a[32:35], v[36:39]
    v_mfma_f32_16x16x32_bf16 v[40:43], v[204:207], a[32:35], v[40:43]
    v_mfma_f32_16x16x32_bf16 v[44:47], v[208:211], a[32:35], v[44:47]
    v_mfma_f32_16x16x32_bf16 v[48:51], v[212:215], a[32:35], v[48:51]
    v_mfma_f32_16x16x32_bf16 v[52:55], v[196:199], a[36:39], v[52:55]
    v_mfma_f32_16x16x32_bf16 v[56:59], v[200:203], a[36:39], v[56:59]
    s_mul_i32 s98, s28, 24576
    s_add_u32 m0, s98, 22528
    s_add_u32 s98, s55, m0
    buffer_load_dwordx4 v8, s[40:43], s98 offen sc1 lds
    v_mfma_f32_16x16x32_bf16 v[60:63], v[204:207], a[36:39], v[60:63]
    v_mfma_f32_16x16x32_bf16 v[64:67], v[208:211], a[36:39], v[64:67]
    v_mfma_f32_16x16x32_bf16 v[68:71], v[212:215], a[36:39], v[68:71]
    v_mfma_f32_16x16x32_bf16 v[72:75], v[196:199], a[40:43], v[72:75]
    v_mfma_f32_16x16x32_bf16 v[76:79], v[200:203], a[40:43], v[76:79]
    v_mfma_f32_16x16x32_bf16 v[80:83], v[204:207], a[40:43], v[80:83]
    v_mfma_f32_16x16x32_bf16 v[84:87], v[208:211], a[40:43], v[84:87]
    s_mul_i32 s98, s28, 24576
    s_add_u32 m0, s98, 23552
    s_add_u32 s98, s55, m0
    buffer_load_dwordx4 v8, s[40:43], s98 offen sc1 lds
    v_mfma_f32_16x16x32_bf16 v[88:91], v[212:215], a[40:43], v[88:91]
    v_mfma_f32_16x16x32_bf16 v[92:95], v[196:199], a[44:47], v[92:95]
    v_mfma_f32_16x16x32_bf16 v[96:99], v[200:203], a[44:47], v[96:99]
    v_mfma_f32_16x16x32_bf16 v[100:103], v[204:207], a[44:47], v[100:103]
    v_mfma_f32_16x16x32_bf16 v[104:107], v[208:211], a[44:47], v[104:107]
    v_mfma_f32_16x16x32_bf16 v[108:111], v[212:215], a[44:47], v[108:111]
    s_waitcnt vmcnt(13)
    v_mfma_f32_16x16x32_bf16 v[32:35], v[216:219], a[48:51], v[32:35]
    s_mul_i32 s98, s28, 11264
    s_add_u32 s98, s98, 98304
    s_add_u32 s98, s55, s98
    buffer_load_dwordx4 a[100:103], v8, s[40:43], s98 offen sc1
    v_mfma_f32_16x16x32_bf16 v[36:39], v[220:223], a[48:51], v[36:39]
    v_mfma_f32_16x16x32_bf16 v[40:43], v[224:227], a[48:51], v[40:43]
    v_mfma_f32_16x16x32_bf16 v[44:47], v[228:231], a[48:51], v[44:47]
    v_mfma_f32_16x16x32_bf16 v[48:51], v[232:235], a[48:51], v[48:51]
    v_mfma_f32_16x16x32_bf16 v[52:55], v[216:219], a[52:55], v[52:55]
    v_mfma_f32_16x16x32_bf16 v[56:59], v[220:223], a[52:55], v[56:59]
    s_mul_i32 s98, s28, 11264
    s_add_u32 s98, s98, 99328
    s_add_u32 s98, s55, s98
    buffer_load_dwordx4 a[104:107], v8, s[40:43], s98 offen sc1
    v_mfma_f32_16x16x32_bf16 v[60:63], v[224:227], a[52:55], v[60:63]
    v_mfma_f32_16x16x32_bf16 v[64:67], v[228:231], a[52:55], v[64:67]
    v_mfma_f32_16x16x32_bf16 v[68:71], v[232:235], a[52:55], v[68:71]
    v_mfma_f32_16x16x32_bf16 v[72:75], v[216:219], a[56:59], v[72:75]
    v_mfma_f32_16x16x32_bf16 v[76:79], v[220:223], a[56:59], v[76:79]
    v_mfma_f32_16x16x32_bf16 v[80:83], v[224:227], a[56:59], v[80:83]
    v_mfma_f32_16x16x32_bf16 v[84:87], v[228:231], a[56:59], v[84:87]
    s_mul_i32 s98, s28, 11264
    s_add_u32 s98, s98, 100352
    s_add_u32 s98, s55, s98
    buffer_load_dwordx4 a[108:111], v8, s[40:43], s98 offen sc1
    v_mfma_f32_16x16x32_bf16 v[88:91], v[232:235], a[56:59], v[88:91]
    v_mfma_f32_16x16x32_bf16 v[92:95], v[216:219], a[60:63], v[92:95]
    v_mfma_f32_16x16x32_bf16 v[96:99], v[220:223], a[60:63], v[96:99]
    v_mfma_f32_16x16x32_bf16 v[100:103], v[224:227], a[60:63], v[100:103]
    v_mfma_f32_16x16x32_bf16 v[104:107], v[228:231], a[60:63], v[104:107]
    v_mfma_f32_16x16x32_bf16 v[108:111], v[232:235], a[60:63], v[108:111]
    s_waitcnt vmcnt(12)
    v_mfma_f32_16x16x32_bf16 v[52:55], v[236:239], a[68:71], v[52:55]
    v_mfma_f32_16x16x32_bf16 v[56:59], v[240:243], a[68:71], v[56:59]
    v_mfma_f32_16x16x32_bf16 v[60:63], v[244:247], a[68:71], v[60:63]
    v_mfma_f32_16x16x32_bf16 v[64:67], v[248:251], a[68:71], v[64:67]
    v_mfma_f32_16x16x32_bf16 v[68:71], v[252:255], a[68:71], v[68:71]
    v_mfma_f32_16x16x32_bf16 v[72:75], v[236:239], a[72:75], v[72:75]
    s_nop 2
    ds_write_b128 v17, v[52:55] offset:0
    v_mfma_f32_16x16x32_bf16 v[76:79], v[240:243], a[72:75], v[76:79]
    ds_write_b128 v17, v[56:59] offset:1024
    v_mfma_f32_16x16x32_bf16 v[80:83], v[244:247], a[72:75], v[80:83]
    ds_write_b128 v17, v[60:63] offset:2048
    v_mfma_f32_16x16x32_bf16 v[84:87], v[248:251], a[72:75], v[84:87]
    ds_write_b128 v17, v[64:67] offset:3072
    v_mfma_f32_16x16x32_bf16 v[88:91], v[252:255], a[72:75], v[88:91]
    ds_write_b128 v17, v[68:71] offset:4096
    v_mfma_f32_16x16x32_bf16 v[92:95], v[236:239], a[76:79], v[92:95]
    ds_write_b128 v18, v[72:75] offset:5120
    v_mfma_f32_16x16x32_bf16 v[96:99], v[240:243], a[76:79], v[96:99]
    ds_write_b128 v18, v[76:79] offset:6144
    v_mfma_f32_16x16x32_bf16 v[100:103], v[244:247], a[76:79], v[100:103]
    ds_write_b128 v18, v[80:83] offset:7168
    v_mfma_f32_16x16x32_bf16 v[104:107], v[248:251], a[76:79], v[104:107]
    ds_write_b128 v18, v[84:87] offset:8192
    v_mfma_f32_16x16x32_bf16 v[108:111], v[252:255], a[76:79], v[108:111]
    ds_write_b128 v18, v[88:91] offset:9216
    v_mfma_f32_16x16x32_bf16 v[32:35], v[236:239], a[64:67], v[32:35]
    ds_write_b128 v19, v[92:95] offset:10240
    v_mfma_f32_16x16x32_bf16 v[36:39], v[240:243], a[64:67], v[36:39]
    ds_write_b128 v19, v[96:99] offset:11264
    v_mfma_f32_16x16x32_bf16 v[40:43], v[244:247], a[64:67], v[40:43]
    ds_write_b128 v19, v[100:103] offset:12288
    v_mfma_f32_16x16x32_bf16 v[44:47], v[248:251], a[64:67], v[44:47]
    ds_write_b128 v19, v[104:107] offset:13312
    v_mfma_f32_16x16x32_bf16 v[48:51], v[252:255], a[64:67], v[48:51]
    ds_write_b128 v19, v[108:111] offset:14336
    s_mul_i32 s98, s28, 11264
    s_add_u32 s98, s98, 101376
    s_add_u32 s98, s55, s98
    buffer_load_dwordx4 a[112:115], v8, s[40:43], s98 offen sc1
    s_mul_i32 s98, s28, 11264
    s_add_u32 s98, s98, 102400
    s_add_u32 s98, s55, s98
    buffer_load_dwordx4 a[116:119], v8, s[40:43], s98 offen sc1
    s_mul_i32 s98, s28, 11264
    s_add_u32 s98, s98, 103424
    s_add_u32 s98, s55, s98
    buffer_load_dwordx4 a[120:123], v8, s[40:43], s98 offen sc1
L_cS4:
    s_mul_i32 s3, s49, 54
    s_add_u32 s3, s3, s28
    s_mul_i32 s54, s3, 5120
    s_add_u32 s54, s54, 819200
    s_mul_i32 s57, s50, 20480
    s_mul_i32 s3, s49, 2560
    s_add_u32 s57, s57, s3
    s_add_u32 s57, s57, s58
    s_add_u32 s57, s57, 163840
    s_mul_i32 s98, s28, 11264
    s_add_u32 s98, s98, 104448
    s_add_u32 s98, s55, s98
    buffer_load_dwordx4 a[124:127], v8, s[40:43], s98 offen sc1
    s_mul_i32 s98, s28, 11264
    s_add_u32 s98, s98, 105472
    s_add_u32 s98, s55, s98
    buffer_load_dwordx4 a[128:131], v8, s[40:43], s98 offen sc1
    s_mul_i32 s98, s28, 11264
    s_add_u32 s98, s98, 106496
    s_add_u32 s98, s55, s98
    buffer_load_dwordx4 a[132:135], v8, s[40:43], s98 offen sc1
    s_mul_i32 s98, s28, 11264
    s_add_u32 s98, s98, 107520
    s_add_u32 s98, s55, s98
    buffer_load_dwordx4 a[136:139], v8, s[40:43], s98 offen sc1
    s_mul_i32 s98, s28, 11264
    s_add_u32 s98, s98, 108544
    s_add_u32 s98, s55, s98
    buffer_load_dwordx4 a[140:143], v8, s[40:43], s98 offen sc1
    buffer_load_dwordx4 v[156:159], v8, s[40:43], s54 offen offset:0 sc1
    s_waitcnt lgkmcnt(0)
    s_barrier
    ds_read_b128 v[52:55], v16 offset:0
    ds_read_b128 v[72:75], v16 offset:5120
    ds_read_b128 v[92:95], v16 offset:10240
    ds_read_b128 v[56:59], v16 offset:1024
    ds_read_b128 v[76:79], v16 offset:6144
    ds_read_b128 v[96:99], v16 offset:11264
    ds_read_b128 v[60:63], v16 offset:2048
    ds_read_b128 v[80:83], v16 offset:7168
    ds_read_b128 v[100:103], v16 offset:12288
    ds_read_b128 v[64:67], v16 offset:3072
    ds_read_b128 v[84:87], v16 offset:8192
    ds_read_b128 v[104:107], v16 offset:13312
    ds_read_b128 v[68:71], v16 offset:4096
    ds_read_b128 v[88:91], v16 offset:9216
    ds_read_b128 v[108:111], v16 offset:14336
    s_waitcnt lgkmcnt(12)
    v_pk_add_f32 v[52:53], v[52:53], v[72:73]
    v_pk_add_f32 v[32:33], v[32:33], v[92:93]
    v_pk_add_f32 v[54:55], v[54:55], v[74:75]
    v_pk_add_f32 v[34:35], v[34:35], v[94:95]
    v_pk_add_f32 v[32:33], v[32:33], v[52:53]
    v_pk_add_f32 v[34:35], v[34:35], v[54:55]
    v_cvt_pk_bf16_f32 v116, v32, v33
    v_cvt_pk_bf16_f32 v117, v34, v35
    s_waitcnt lgkmcnt(9)
    v_pk_add_f32 v[56:57], v[56:57], v[76:77]
    v_pk_add_f32 v[36:37], v[36:37], v[96:97]
    v_pk_add_f32 v[58:59], v[58:59], v[78:79]
    v_pk_add_f32 v[38:39], v[38:39], v[98:99]
    v_pk_add_f32 v[36:37], v[36:37], v[56:57]
    v_pk_add_f32 v[38:39], v[38:39], v[58:59]
    v_cvt_pk_bf16_f32 v118, v36, v37
    v_cvt_pk_bf16_f32 v119, v38, v39
    buffer_store_dwordx4 v[116:119], v8, s[40:43], s57 offen sc1
    s_waitcnt lgkmcnt(6)
    v_pk_add_f32 v[60:61], v[60:61], v[80:81]
    v_pk_add_f32 v[40:41], v[40:41], v[100:101]
    v_pk_add_f32 v[62:63], v[62:63], v[82:83]
    v_pk_add_f32 v[42:43], v[42:43], v[102:103]
    v_pk_add_f32 v[40:41], v[40:41], v[60:61]
    v_pk_add_f32 v[42:43], v[42:43], v[62:63]
    v_cvt_pk_bf16_f32 v120, v40, v41
    v_cvt_pk_bf16_f32 v121, v42, v43
    s_waitcnt lgkmcnt(3)
    v_pk_add_f32 v[64:65], v[64:65], v[84:85]
    v_pk_add_f32 v[44:45], v[44:45], v[104:105]
    v_pk_add_f32 v[66:67], v[66:67], v[86:87]
    v_pk_add_f32 v[46:47], v[46:47], v[106:107]
    v_pk_add_f32 v[44:45], v[44:45], v[64:65]
    v_pk_add_f32 v[46:47], v[46:47], v[66:67]
    v_cvt_pk_bf16_f32 v122, v44, v45
    v_cvt_pk_bf16_f32 v123, v46, v47
    buffer_store_dwordx4 v[120:123], v8, s[40:43], s57 offen offset:1024 sc1
    s_waitcnt lgkmcnt(0)
    v_pk_add_f32 v[68:69], v[68:69], v[88:89]
    v_pk_add_f32 v[48:49], v[48:49], v[108:109]
    v_pk_add_f32 v[70:71], v[70:71], v[90:91]
    v_pk_add_f32 v[50:51], v[50:51], v[110:111]
    v_pk_add_f32 v[48:49], v[48:49], v[68:69]
    v_pk_add_f32 v[50:51], v[50:51], v[70:71]
    v_cvt_pk_bf16_f32 v124, v48, v49
    v_cvt_pk_bf16_f32 v125, v50, v51
    buffer_store_dwordx2 v[124:125], v13, s[40:43], s57 offen offset:2048 sc1
    v_pk_add_f32 v[28:29], v[32:33], v[34:35]
    v_pk_mul_f32 v[30:31], v[32:33], v[32:33]
    s_nop 0
    v_pk_fma_f32 v[30:31], v[34:35], v[34:35], v[30:31]
    v_pk_add_f32 v[28:29], v[28:29], v[36:37]
    v_pk_fma_f32 v[30:31], v[36:37], v[36:37], v[30:31]
    v_pk_add_f32 v[28:29], v[28:29], v[38:39]
    v_pk_fma_f32 v[30:31], v[38:39], v[38:39], v[30:31]
    v_pk_add_f32 v[28:29], v[28:29], v[40:41]
    v_pk_fma_f32 v[30:31], v[40:41], v[40:41], v[30:31]
    v_pk_add_f32 v[28:29], v[28:29], v[42:43]
    v_pk_fma_f32 v[30:31], v[42:43], v[42:43], v[30:31]
    v_pk_add_f32 v[28:29], v[28:29], v[44:45]
    v_pk_fma_f32 v[30:31], v[44:45], v[44:45], v[30:31]
    v_pk_add_f32 v[28:29], v[28:29], v[46:47]
    v_pk_fma_f32 v[30:31], v[46:47], v[46:47], v[30:31]
    v_pk_add_f32 v[28:29], v[28:29], v[48:49]
    v_pk_fma_f32 v[30:31], v[48:49], v[48:49], v[30:31]
    v_pk_add_f32 v[28:29], v[28:29], v[50:51]
    v_pk_fma_f32 v[30:31], v[50:51], v[50:51], v[30:31]
    v_add_f32 v20, v28, v29
    v_add_f32 v21, v30, v31
    v_mov_b32 v22, v20
    s_nop 1
    v_permlane32_swap_b32 v20, v22
    v_add_f32 v20, v20, v22
    v_mov_b32 v22, v20
    s_nop 1
    v_permlane16_swap_b32 v20, v22
    v_add_f32 v20, v20, v22
    v_mov_b32 v22, v21
    s_nop 1
    v_permlane32_swap_b32 v21, v22
    v_add_f32 v21, v21, v22
    v_mov_b32 v22, v21
    s_nop 1
    v_permlane16_swap_b32 v21, v22
    v_add_f32 v21, v21, v22
    v_lshlrev_b32 v22, 1, v10
    s_lshl_b32 s57, s50, 10
    s_lshl_b32 s3, s49, 7
    s_add_u32 s57, s57, s3
    s_add_u32 s57, s57, s58
    s_add_u32 s57, s57, 327680
    buffer_store_dwordx2 v[20:21], v22, s[40:43], s57 offen sc1
    s_mul_i32 s3, s28, 40960
    s_add_u32 s3, s3, s58
    s_add_u32 s80, s3, 163840
    s_add_u32 s81, s80, 20480
    s_lshl_b32 s82, s28, 11
    s_add_u32 s82, s82, s58
    s_add_u32 s82, s82, 327680
    v_lshlrev_b32 v19, 8, v11
    v_lshl_add_u32 v19, v10, 1, v19
    v_add_u32 v16, 57344, v8
    v_add_u32 v17, 114688, v8
    s_mul_i32 s3, s28, 11264
    s_add_u32 s3, s3, 98304
    v_add_u32 v18, s3, v8
    v_add_f32 v126, v126, v130
    v_add_f32 v134, v134, v138
    v_add_f32 v126, v126, v142
    v_add_f32 v126, v126, v134
    v_add_f32 v127, v127, v131
    v_add_f32 v135, v135, v139
    v_add_f32 v127, v127, v143
    v_add_f32 v127, v127, v135
    v_add_f32 v128, v128, v132
    v_add_f32 v136, v136, v140
    v_add_f32 v128, v128, v144
    v_add_f32 v128, v128, v136
    v_add_f32 v129, v129, v133
    v_add_f32 v137, v137, v141
    v_add_f32 v129, v129, v145
    v_add_f32 v129, v129, v137
    s_lshl_b32 s3, s28, 9
    s_add_u32 s3, s3, 144384
    v_add_u32 v29, s3, v26
    s_add_u32 s59, s58, 336000
    s_lshl_b32 s3, s27, 2
    s_add_u32 s3, s3, s59
    s_waitcnt vmcnt(0)
    s_barrier
    s_cmp_lg_u32 s28, 0
    s_cbranch_scc1 L_g1np
    s_mov_b64 exec, 1
    s_cmp_eq_u32 s79, 0
    s_cbranch_scc1 L_g1slow
    buffer_store_dword v6, v5, s[40:43], s3 offen
    s_branch L_g1pd
L_g1slow:
    buffer_store_dword v6, v5, s[40:43], s3 offen sc1
L_g1pd:
    s_mov_b64 exec, -1
L_g1np:
    s_waitcnt vmcnt(5)
    ds_write_b128 v18, a[100:103] offset:0
    ds_write_b128 v18, a[104:107] offset:1024
    ds_write_b128 v18, a[108:111] offset:2048
    ds_write_b128 v18, a[112:115] offset:3072
    ds_write_b128 v18, a[116:119] offset:4096
    ds_write_b128 v18, a[120:123] offset:5120
    ds_write_b128 v18, a[124:127] offset:6144
    ds_write_b128 v18, a[128:131] offset:7168
    ds_write_b128 v18, a[132:135] offset:8192
    ds_write_b128 v18, a[136:139] offset:9216
    ds_write_b128 v18, a[140:143] offset:10240
    s_mov_b64 exec, s[66:67]
    ds_write_b128 v29, v[126:129]
    s_mov_b64 exec, -1
    s_waitcnt lgkmcnt(0)
    buffer_load_dwordx4 v[160:163], v8, s[40:43], s54 offen offset:1024 sc1
    buffer_load_dwordx4 v[164:167], v8, s[40:43], s54 offen offset:2048 sc1
    buffer_load_dwordx4 v[168:171], v8, s[40:43], s54 offen offset:3072 sc1
    buffer_load_dwordx4 v[172:175], v12, s[40:43], s54 offen offset:0 sc1
    s_add_u32 s54, s54, 20480
    buffer_load_dwordx4 v[176:179], v8, s[40:43], s54 offen offset:0 sc1
    buffer_load_dwordx4 v[180:183], v8, s[40:43], s54 offen offset:1024 sc1
    s_cmp_lg_u32 s28, 0
    s_cbranch_scc1 L_g1j
    s_mov_b32 s78, 0
L_g1p:
    buffer_load_dword v27, v10, s[40:43], s59 offen sc1
    s_add_u32 s78, s78, 1
    s_waitcnt vmcnt(0)
    v_cmp_ne_u32 vcc, s76, v27
    s_cmp_ge_u32 s78, 32768
    s_cbranch_scc1 L_g1x
    s_cbranch_vccnz L_g1p
L_g1x:
L_g1j:
    s_barrier
    buffer_load_dwordx4 a[0:3], v8, s[40:43], s80 offen offset:0 sc1
    buffer_load_dwordx4 a[4:7], v8, s[40:43], s81 offen offset:0 sc1
    buffer_load_dwordx4 a[8:11], v8, s[40:43], s80 offen offset:1024 sc1
    buffer_load_dwordx4 a[12:15], v8, s[40:43], s81 offen offset:1024 sc1
    buffer_load_dwordx4 a[16:19], v8, s[40:43], s80 offen offset:2048 sc1
    buffer_load_dwordx4 a[20:23], v8, s[40:43], s81 offen offset:2048 sc1
    buffer_load_dwordx4 a[24:27], v8, s[40:43], s80 offen offset:3072 sc1
    s_add_u32 s80, s80, 4096
    buffer_load_dwordx4 a[28:31], v8, s[40:43], s81 offen offset:3072 sc1
    s_add_u32 s81, s81, 4096
    buffer_load_dwordx4 a[32:35], v8, s[40:43], s80 offen offset:0 sc1
    buffer_load_dwordx4 a[36:39], v8, s[40:43], s81 offen offset:0 sc1
    buffer_load_dwordx4 a[40:43], v8, s[40:43], s80 offen offset:1024 sc1
    buffer_load_dwordx4 a[44:47], v8, s[40:43], s81 offen offset:1024 sc1
    buffer_load_dwordx2 v[88:89], v19, s[40:43], s82 offen offset:0 sc1
    buffer_load_dwordx2 v[90:91], v19, s[40:43], s82 offen offset:128 sc1
    buffer_load_dwordx2 v[92:93], v19, s[40:43], s82 offen offset:1024 sc1
    buffer_load_dwordx2 v[94:95], v19, s[40:43], s82 offen offset:1152 sc1
    ds_read_b128 a[160:163], v8 offset:0
    ds_read_b128 a[164:167], v8 offset:1024
    ds_read_b128 a[168:171], v8 offset:2048
    ds_read_b128 a[172:175], v8 offset:3072
    v_add_u32 v18, 144384, v23
    s_mov_b32 s60, 0xc0135761
    s_mov_b32 s61, 0xbdd2d3e8
    s_mul_i32 s72, s28, 110592
    s_add_u32 s72, s72, s58
    s_add_u32 s72, s72, 336896
    s_lshl_b32 s3, s27, 11
    s_add_u32 s56, s72, s3
    s_add_u32 s57, s56, 55296
    s_lshl_b32 s3, s27, 10
    s_add_u32 s70, s72, s3
    s_add_u32 s70, s70, 32768
    s_add_u32 s71, s70, 55296
    s_lshr_b32 s3, s27, 2
    s_sub_u32 s3, s27, s3
    s_lshl_b32 s3, s3, 9
    s_add_u32 s72, s72, s3
    s_add_u32 s72, s72, 48640
    s_and_b32 s3, s27, 3
    s_cselect_b32 s72, s72, 0x40000000
    s_add_u32 s73, s72, 55296
    s_waitcnt vmcnt(14) lgkmcnt(0)
    v_mfma_f32_16x16x32_bf16 v[32:35], a[160:163], a[0:3], 0
    ds_read_b128 a[176:179], v8 offset:7168
    buffer_load_dwordx4 a[48:51], v8, s[40:43], s80 offen offset:2048 sc1
    v_mfma_f32_16x16x32_bf16 v[60:63], a[160:163], a[4:7], 0
    ds_read_b128 a[180:183], v8 offset:8192
    v_mfma_f32_16x16x32_bf16 v[36:39], a[164:167], a[0:3], 0
    ds_read_b128 a[184:187], v8 offset:9216
    v_mfma_f32_16x16x32_bf16 v[64:67], a[164:167], a[4:7], 0
    ds_read_b128 a[188:191], v8 offset:10240
    v_mfma_f32_16x16x32_bf16 v[40:43], a[168:171], a[0:3], 0
    ds_read_b128 v[128:131], v18 offset:0
    buffer_load_dwordx4 a[52:55], v8, s[40:43], s81 offen offset:2048 sc1
    v_mfma_f32_16x16x32_bf16 v[68:71], a[168:171], a[4:7], 0
    ds_read_b128 v[96:99], v18 offset:512
    v_mfma_f32_16x16x32_bf16 v[44:47], a[172:175], a[0:3], 0
    ds_read_b128 v[100:103], v18 offset:1024
    v_mfma_f32_16x16x32_bf16 v[72:75], a[172:175], a[4:7], 0
    ds_read_b128 v[104:107], v18 offset:1536
    s_waitcnt vmcnt(14) lgkmcnt(4)
    v_mfma_f32_16x16x32_bf16 v[32:35], a[176:179], a[8:11], v[32:35]
    ds_read_b128 a[160:163], v8 offset:14336
    buffer_load_dwordx4 a[56:59], v8, s[40:43], s80 offen offset:3072 sc1
    s_add_u32 s80, s80, 4096
    buffer_load_dwordx4 a[60:63], v8, s[40:43], s81 offen offset:3072 sc1
    s_add_u32 s81, s81, 4096
    v_mfma_f32_16x16x32_bf16 v[60:63], a[176:179], a[12:15], v[60:63]
    ds_read_b128 a[164:167], v8 offset:15360
    s_waitcnt lgkmcnt(2)
    v_add_f32 v128, v128, v96
    v_mfma_f32_16x16x32_bf16 v[36:39], a[180:183], a[8:11], v[36:39]
    ds_read_b128 a[168:171], v8 offset:16384
    v_add_f32 v100, v100, v104
    v_add_f32 v128, v128, v100
    v_mfma_f32_16x16x32_bf16 v[64:67], a[180:183], a[12:15], v[64:67]
    ds_read_b128 a[172:175], v8 offset:17408
    v_add_f32 v129, v129, v97
    v_add_f32 v101, v101, v105
    v_mfma_f32_16x16x32_bf16 v[40:43], a[184:187], a[8:11], v[40:43]
    ds_read_b128 v[132:135], v18 offset:64
    v_add_f32 v129, v129, v101
    v_add_f32 v130, v130, v98
    v_mfma_f32_16x16x32_bf16 v[68:71], a[184:187], a[12:15], v[68:71]
    ds_read_b128 v[220:223], v18 offset:576
    v_add_f32 v102, v102, v106
    v_add_f32 v130, v130, v102
    v_mfma_f32_16x16x32_bf16 v[44:47], a[188:191], a[8:11], v[44:47]
    ds_read_b128 v[224:227], v18 offset:1088
    v_add_f32 v131, v131, v99
    v_add_f32 v103, v103, v107
    v_mfma_f32_16x16x32_bf16 v[72:75], a[188:191], a[12:15], v[72:75]
    ds_read_b128 v[228:231], v18 offset:1600
    v_add_f32 v131, v131, v103
    s_waitcnt vmcnt(14) lgkmcnt(4)
    v_mfma_f32_16x16x32_bf16 v[32:35], a[160:163], a[16:19], v[32:35]
    ds_read_b128 a[176:179], v8 offset:21504
    buffer_load_dwordx4 a[64:67], v8, s[40:43], s80 offen offset:0 sc1
    buffer_load_dwordx4 a[68:71], v8, s[40:43], s81 offen offset:0 sc1
    v_mfma_f32_16x16x32_bf16 v[60:63], a[160:163], a[20:23], v[60:63]
    ds_read_b128 a[180:183], v8 offset:22528
    s_waitcnt lgkmcnt(2)
    v_add_f32 v132, v132, v220
    v_mfma_f32_16x16x32_bf16 v[36:39], a[164:167], a[16:19], v[36:39]
    ds_read_b128 a[184:187], v8 offset:23552
    v_add_f32 v224, v224, v228
    v_add_f32 v132, v132, v224
    v_mfma_f32_16x16x32_bf16 v[64:67], a[164:167], a[20:23], v[64:67]
    ds_read_b128 a[188:191], v8 offset:24576
    v_add_f32 v133, v133, v221
    v_add_f32 v225, v225, v229
    v_mfma_f32_16x16x32_bf16 v[40:43], a[168:171], a[16:19], v[40:43]
    ds_read_b128 v[136:139], v18 offset:128
    v_add_f32 v133, v133, v225
    v_add_f32 v134, v134, v222
    v_mfma_f32_16x16x32_bf16 v[68:71], a[168:171], a[20:23], v[68:71]
    ds_read_b128 v[96:99], v18 offset:640
    v_add_f32 v226, v226, v230
    v_add_f32 v134, v134, v226
    v_mfma_f32_16x16x32_bf16 v[44:47], a[172:175], a[16:19], v[44:47]
    ds_read_b128 v[100:103], v18 offset:1152
    v_add_f32 v135, v135, v223
    v_add_f32 v227, v227, v231
    v_mfma_f32_16x16x32_bf16 v[72:75], a[172:175], a[20:23], v[72:75]
    ds_read_b128 v[104:107], v18 offset:1664
    v_add_f32 v135, v135, v227
    s_waitcnt vmcnt(14) lgkmcnt(4)
    v_mfma_f32_16x16x32_bf16 v[32:35], a[176:179], a[24:27], v[32:35]
    ds_read_b128 a[160:163], v8 offset:28672
    buffer_load_dwordx4 a[72:75], v8, s[40:43], s80 offen offset:1024 sc1
    buffer_load_dwordx4 a[76:79], v8, s[40:43], s81 offen offset:1024 sc1
    v_mfma_f32_16x16x32_bf16 v[60:63], a[176:179], a[28:31], v[60:63]
    ds_read_b128 a[164:167], v8 offset:29696
    s_waitcnt lgkmcnt(2)
    v_add_f32 v136, v136, v96
    v_mfma_f32_16x16x32_bf16 v[36:39], a[180:183], a[24:27], v[36:39]
    ds_read_b128 a[168:171], v8 offset:30720
    v_add_f32 v100, v100, v104
    v_add_f32 v136, v136, v100
    v_mfma_f32_16x16x32_bf16 v[64:67], a[180:183], a[28:31], v[64:67]
    ds_read_b128 a[172:175], v8 offset:31744
    v_add_f32 v137, v137, v97
    v_add_f32 v101, v101, v105
    v_mfma_f32_16x16x32_bf16 v[40:43], a[184:187], a[24:27], v[40:43]
    ds_read_b128 v[140:143], v18 offset:192
    v_add_f32 v137, v137, v101
    v_add_f32 v138, v138, v98
    v_mfma_f32_16x16x32_bf16 v[68:71], a[184:187], a[28:31], v[68:71]
    ds_read_b128 v[220:223], v18 offset:704
    v_add_f32 v102, v102, v106
    v_add_f32 v138, v138, v102
    v_mfma_f32_16x16x32_bf16 v[44:47], a[188:191], a[24:27], v[44:47]
    ds_read_b128 v[224:227], v18 offset:1216
    v_add_f32 v139, v139, v99
    v_add_f32 v103, v103, v107
    v_mfma_f32_16x16x32_bf16 v[72:75], a[188:191], a[28:31], v[72:75]
    ds_read_b128 v[228:231], v18 offset:1728
    v_add_f32 v139, v139, v103
    s_waitcnt vmcnt(14) lgkmcnt(4)
    v_mfma_f32_16x16x32_bf16 v[32:35], a[160:163], a[32:35], v[32:35]
    ds_read_b128 a[176:179], v8 offset:35840
    buffer_load_dwordx4 a[80:83], v8, s[40:43], s80 offen offset:2048 sc1
    buffer_load_dwordx4 a[84:87], v8, s[40:43], s81 offen offset:2048 sc1
    v_mfma_f32_16x16x32_bf16 v[60:63], a[160:163], a[36:39], v[60:63]
    ds_read_b128 a[180:183], v8 offset:36864
    s_waitcnt lgkmcnt(2)
    v_add_f32 v140, v140, v220
    v_mfma_f32_16x16x32_bf16 v[36:39], a[164:167], a[32:35], v[36:39]
    ds_read_b128 a[184:187], v8 offset:37888
    v_add_f32 v224, v224, v228
    v_add_f32 v140, v140, v224
    v_mfma_f32_16x16x32_bf16 v[64:67], a[164:167], a[36:39], v[64:67]
    ds_read_b128 a[188:191], v8 offset:38912
    v_add_f32 v141, v141, v221
    v_add_f32 v225, v225, v229
    v_mfma_f32_16x16x32_bf16 v[40:43], a[168:171], a[32:35], v[40:43]
    ds_read_b128 v[144:147], v18 offset:256
    v_add_f32 v141, v141, v225
    v_add_f32 v142, v142, v222
    v_mfma_f32_16x16x32_bf16 v[68:71], a[168:171], a[36:39], v[68:71]
    ds_read_b128 v[96:99], v18 offset:768
    v_add_f32 v226, v226, v230
    v_add_f32 v142, v142, v226
    v_mfma_f32_16x16x32_bf16 v[44:47], a[172:175], a[32:35], v[44:47]
    ds_read_b128 v[100:103], v18 offset:1280
    v_add_f32 v143, v143, v223
    v_add_f32 v227, v227, v231
    v_mfma_f32_16x16x32_bf16 v[72:75], a[172:175], a[36:39], v[72:75]
    ds_read_b128 v[104:107], v18 offset:1792
    v_add_f32 v143, v143, v227
    s_waitcnt vmcnt(14) lgkmcnt(4)
    v_mfma_f32_16x16x32_bf16 v[32:35], a[176:179], a[40:43], v[32:35]
    ds_read_b128 a[160:163], v8 offset:43008
    buffer_load_dwordx4 a[88:91], v8, s[40:43], s80 offen offset:3072 sc1
    s_add_u32 s80, s80, 4096
    buffer_load_dwordx4 a[92:95], v8, s[40:43], s81 offen offset:3072 sc1
    s_add_u32 s81, s81, 4096
    v_mfma_f32_16x16x32_bf16 v[60:63], a[176:179], a[44:47], v[60:63]
    ds_read_b128 a[164:167], v8 offset:44032
    s_waitcnt lgkmcnt(2)
    v_add_f32 v144, v144, v96
    v_mfma_f32_16x16x32_bf16 v[36:39], a[180:183], a[40:43], v[36:39]
    ds_read_b128 a[168:171], v8 offset:45056
    v_add_f32 v100, v100, v104
    v_add_f32 v144, v144, v100
    v_mfma_f32_16x16x32_bf16 v[64:67], a[180:183], a[44:47], v[64:67]
    ds_read_b128 a[172:175], v8 offset:46080
    v_add_f32 v145, v145, v97
    v_add_f32 v101, v101, v105
    v_mfma_f32_16x16x32_bf16 v[40:43], a[184:187], a[40:43], v[40:43]
    ds_read_b128 v[148:151], v18 offset:320
    v_add_f32 v145, v145, v101
    v_add_f32 v146, v146, v98
    v_mfma_f32_16x16x32_bf16 v[68:71], a[184:187], a[44:47], v[68:71]
    ds_read_b128 v[220:223], v18 offset:832
    v_add_f32 v102, v102, v106
    v_add_f32 v146, v146, v102
    v_mfma_f32_16x16x32_bf16 v[44:47], a[188:191], a[40:43], v[44:47]
    ds_read_b128 v[224:227], v18 offset:1344
    v_add_f32 v147, v147, v99
    v_add_f32 v103, v103, v107
    v_mfma_f32_16x16x32_bf16 v[72:75], a[188:191], a[44:47], v[72:75]
    ds_read_b128 v[228:231], v18 offset:1856
    v_add_f32 v147, v147, v103
    s_waitcnt vmcnt(10) lgkmcnt(4)
    v_mfma_f32_16x16x32_bf16 v[32:35], a[160:163], a[48:51], v[32:35]
    ds_read_b128 a[176:179], v8 offset:50176
    buffer_load_dwordx4 a[96:99], v8, s[40:43], s80 offen offset:0 sc1
    buffer_load_dwordx4 a[100:103], v8, s[40:43], s81 offen offset:0 sc1
    v_mfma_f32_16x16x32_bf16 v[60:63], a[160:163], a[52:55], v[60:63]
    ds_read_b128 a[180:183], v8 offset:51200
    s_waitcnt lgkmcnt(2)
    v_add_f32 v148, v148, v220
    v_mfma_f32_16x16x32_bf16 v[36:39], a[164:167], a[48:51], v[36:39]
    ds_read_b128 a[184:187], v8 offset:52224
    v_add_f32 v224, v224, v228
    v_add_f32 v148, v148, v224
    v_mfma_f32_16x16x32_bf16 v[64:67], a[164:167], a[52:55], v[64:67]
    ds_read_b128 a[188:191], v8 offset:53248
    v_add_f32 v149, v149, v221
    v_add_f32 v225, v225, v229
    v_mfma_f32_16x16x32_bf16 v[40:43], a[168:171], a[48:51], v[40:43]
    ds_read_b128 v[152:155], v18 offset:384
    v_add_f32 v149, v149, v225
    v_add_f32 v150, v150, v222
    v_mfma_f32_16x16x32_bf16 v[68:71], a[168:171], a[52:55], v[68:71]
    ds_read_b128 v[96:99], v18 offset:896
    v_add_f32 v226, v226, v230
    v_add_f32 v150, v150, v226
    v_mfma_f32_16x16x32_bf16 v[44:47], a[172:175], a[48:51], v[44:47]
    ds_read_b128 v[100:103], v18 offset:1408
    v_add_f32 v151, v151, v223
    v_add_f32 v227, v227, v231
    v_mfma_f32_16x16x32_bf16 v[72:75], a[172:175], a[52:55], v[72:75]
    ds_read_b128 v[104:107], v18 offset:1920
    v_add_f32 v151, v151, v227
    s_waitcnt vmcnt(10) lgkmcnt(4)
    v_mfma_f32_16x16x32_bf16 v[32:35], a[176:179], a[56:59], v[32:35]
    ds_read_b128 a[160:163], v16 offset:0
    buffer_load_dwordx4 a[104:107], v8, s[40:43], s80 offen offset:1024 sc1
    buffer_load_dwordx4 a[108:111], v8, s[40:43], s81 offen offset:1024 sc1
    v_mfma_f32_16x16x32_bf16 v[60:63], a[176:179], a[60:63], v[60:63]
    ds_read_b128 a[164:167], v16 offset:1024
    s_waitcnt lgkmcnt(2)
    v_add_f32 v152, v152, v96
    v_mfma_f32_16x16x32_bf16 v[36:39], a[180:183], a[56:59], v[36:39]
    ds_read_b128 a[168:171], v16 offset:2048
    v_add_f32 v100, v100, v104
    v_add_f32 v152, v152, v100
    v_mfma_f32_16x16x32_bf16 v[64:67], a[180:183], a[60:63], v[64:67]
    ds_read_b128 a[172:175], v16 offset:3072
    v_add_f32 v153, v153, v97
    v_add_f32 v101, v101, v105
    v_mfma_f32_16x16x32_bf16 v[40:43], a[184:187], a[56:59], v[40:43]
    v_add_f32 v153, v153, v101
    v_add_f32 v154, v154, v98
    v_mfma_f32_16x16x32_bf16 v[68:71], a[184:187], a[60:63], v[68:71]
    v_add_f32 v102, v102, v106
    v_add_f32 v154, v154, v102
    v_mfma_f32_16x16x32_bf16 v[44:47], a[188:191], a[56:59], v[44:47]
    v_add_f32 v155, v155, v99
    v_add_f32 v103, v103, v107
    v_mfma_f32_16x16x32_bf16 v[72:75], a[188:191], a[60:63], v[72:75]
    v_add_f32 v155, v155, v103
    s_waitcnt vmcnt(10) lgkmcnt(0)
    v_mfma_f32_16x16x32_bf16 v[32:35], a[160:163], a[64:67], v[32:35]
    ds_read_b128 a[176:179], v16 offset:7168
    buffer_load_dwordx4 a[112:115], v8, s[40:43], s80 offen offset:2048 sc1
    v_mfma_f32_16x16x32_bf16 v[60:63], a[160:163], a[68:71], v[60:63]
    ds_read_b128 a[180:183], v16 offset:8192
    buffer_load_dwordx4 a[116:119], v8, s[40:43], s81 offen offset:2048 sc1
    v_mfma_f32_16x16x32_bf16 v[36:39], a[164:167], a[64:67], v[36:39]
    ds_read_b128 a[184:187], v16 offset:9216
    v_add_f32 v20, v88, v90
    v_mfma_f32_16x16x32_bf16 v[64:67], a[164:167], a[68:71], v[64:67]
    ds_read_b128 a[188:191], v16 offset:10240
    v_add_f32 v24, v89, v91
    v_mfma_f32_16x16x32_bf16 v[40:43], a[168:171], a[64:67], v[40:43]
    v_add_f32 v21, v92, v94
    v_mfma_f32_16x16x32_bf16 v[68:71], a[168:171], a[68:71], v[68:71]
    v_add_f32 v25, v93, v95
    v_mfma_f32_16x16x32_bf16 v[44:47], a[172:175], a[64:67], v[44:47]
    v_mov_b32 v22, v20
    s_nop 1
    v_permlane32_swap_b32 v20, v22
    v_add_f32 v20, v20, v22
    v_mov_b32 v22, v20
    s_nop 1
    v_permlane16_swap_b32 v20, v22
    v_add_f32 v20, v20, v22
    v_mov_b32 v22, v21
    s_nop 1
    v_permlane32_swap_b32 v21, v22
    v_add_f32 v21, v21, v22
    v_mov_b32 v22, v21
    s_nop 1
    v_permlane16_swap_b32 v21, v22
    v_add_f32 v21, v21, v22
    v_mov_b32 v22, v24
    s_nop 1
    v_permlane32_swap_b32 v24, v22
    v_add_f32 v24, v24, v22
    v_mov_b32 v22, v24
    s_nop 1
    v_permlane16_swap_b32 v24, v22
    v_add_f32 v24, v24, v22
    v_mov_b32 v22, v25
    s_nop 1
    v_permlane32_swap_b32 v25, v22
    v_add_f32 v25, v25, v22
    v_mov_b32 v22, v25
    s_nop 1
    v_permlane16_swap_b32 v25, v22
    v_add_f32 v25, v25, v22
    v_mfma_f32_16x16x32_bf16 v[72:75], a[172:175], a[68:71], v[72:75]
    s_waitcnt vmcnt(10) lgkmcnt(0)
    v_mfma_f32_16x16x32_bf16 v[32:35], a[176:179], a[72:75], v[32:35]
    ds_read_b128 a[160:163], v16 offset:14336
    buffer_load_dwordx4 a[120:123], v8, s[40:43], s80 offen offset:3072 sc1
    s_add_u32 s80, s80, 4096
    buffer_load_dwordx4 a[124:127], v8, s[40:43], s81 offen offset:3072 sc1
    s_add_u32 s81, s81, 4096
    v_mul_f32 v20, s63, v20
    v_mfma_f32_16x16x32_bf16 v[60:63], a[176:179], a[76:79], v[60:63]
    ds_read_b128 a[164:167], v16 offset:15360
    v_mul_f32 v24, s63, v24
    v_fma_f32 v24, -v20, v20, v24
    v_max_f32 v24, 0, v24
    v_mfma_f32_16x16x32_bf16 v[36:39], a[180:183], a[72:75], v[36:39]
    ds_read_b128 a[168:171], v16 offset:16384
    v_add_f32 v22, s64, v24
    v_fma_f32 v24, v22, s64, v24
    v_rsq_f32 v24, v24
    v_mfma_f32_16x16x32_bf16 v[64:67], a[180:183], a[76:79], v[64:67]
    ds_read_b128 a[172:175], v16 offset:17408
    v_mul_f32 v20, v20, v24
    v_mul_f32 v21, s63, v21
    v_mfma_f32_16x16x32_bf16 v[40:43], a[184:187], a[72:75], v[40:43]
    v_mul_f32 v25, s63, v25
    v_fma_f32 v25, -v21, v21, v25
    v_max_f32 v25, 0, v25
    v_mfma_f32_16x16x32_bf16 v[68:71], a[184:187], a[76:79], v[68:71]
    v_add_f32 v22, s64, v25
    v_fma_f32 v25, v22, s64, v25
    v_rsq_f32 v25, v25
    v_mfma_f32_16x16x32_bf16 v[44:47], a[188:191], a[72:75], v[44:47]
    v_mul_f32 v21, v21, v25
    v_mov_b32 v252, s60
    v_mov_b32 v253, s60
    v_mfma_f32_16x16x32_bf16 v[72:75], a[188:191], a[76:79], v[72:75]
    s_mov_b32 s96, s61
    s_mov_b32 s97, s61
    s_waitcnt vmcnt(10) lgkmcnt(0)
    v_mfma_f32_16x16x32_bf16 v[32:35], a[160:163], a[80:83], v[32:35]
    ds_read_b128 a[176:179], v16 offset:21504
    buffer_load_dwordx4 a[128:131], v8, s[40:43], s80 offen offset:0 sc1
    v_mfma_f32_16x16x32_bf16 v[60:63], a[160:163], a[84:87], v[60:63]
    ds_read_b128 a[180:183], v16 offset:22528
    v_mfma_f32_16x16x32_bf16 v[36:39], a[164:167], a[80:83], v[36:39]
    ds_read_b128 a[184:187], v16 offset:23552
    v_mfma_f32_16x16x32_bf16 v[64:67], a[164:167], a[84:87], v[64:67]
    ds_read_b128 a[188:191], v16 offset:24576
    v_mfma_f32_16x16x32_bf16 v[40:43], a[168:171], a[80:83], v[40:43]
    buffer_load_dwordx4 a[132:135], v8, s[40:43], s81 offen offset:0 sc1
    v_mfma_f32_16x16x32_bf16 v[68:71], a[168:171], a[84:87], v[68:71]
    v_mfma_f32_16x16x32_bf16 v[44:47], a[172:175], a[80:83], v[44:47]
    v_mfma_f32_16x16x32_bf16 v[72:75], a[172:175], a[84:87], v[72:75]
    s_waitcnt vmcnt(10) lgkmcnt(0)
    v_mfma_f32_16x16x32_bf16 v[32:35], a[176:179], a[88:91], v[32:35]
    ds_read_b128 a[160:163], v16 offset:28672
    buffer_load_dwordx4 a[136:139], v8, s[40:43], s80 offen offset:1024 sc1
    v_mfma_f32_16x16x32_bf16 v[60:63], a[176:179], a[92:95], v[60:63]
    ds_read_b128 a[164:167], v16 offset:29696
    v_mfma_f32_16x16x32_bf16 v[36:39], a[180:183], a[88:91], v[36:39]
    ds_read_b128 a[168:171], v16 offset:30720
    v_mfma_f32_16x16x32_bf16 v[64:67], a[180:183], a[92:95], v[64:67]
    ds_read_b128 a[172:175], v16 offset:31744
    v_mfma_f32_16x16x32_bf16 v[40:43], a[184:187], a[88:91], v[40:43]
    buffer_load_dwordx4 a[140:143], v8, s[40:43], s81 offen offset:1024 sc1
    v_mfma_f32_16x16x32_bf16 v[68:71], a[184:187], a[92:95], v[68:71]
    v_mfma_f32_16x16x32_bf16 v[44:47], a[188:191], a[88:91], v[44:47]
    v_mfma_f32_16x16x32_bf16 v[72:75], a[188:191], a[92:95], v[72:75]
    s_waitcnt vmcnt(10) lgkmcnt(0)
    v_mfma_f32_16x16x32_bf16 v[32:35], a[160:163], a[96:99], v[32:35]
    ds_read_b128 a[176:179], v16 offset:35840
    buffer_load_dwordx4 a[144:147], v8, s[40:43], s80 offen offset:2048 sc1
    v_mfma_f32_16x16x32_bf16 v[60:63], a[160:163], a[100:103], v[60:63]
    ds_read_b128 a[180:183], v16 offset:36864
    buffer_load_dwordx4 a[148:151], v8, s[40:43], s81 offen offset:2048 sc1
    v_mfma_f32_16x16x32_bf16 v[36:39], a[164:167], a[96:99], v[36:39]
    ds_read_b128 a[184:187], v16 offset:37888
    v_accvgpr_read_b32 v27, a204
    v_mfma_f32_16x16x32_bf16 v[64:67], a[164:167], a[100:103], v[64:67]
    ds_read_b128 a[188:191], v16 offset:38912
    v_lshlrev_b32 v220, 16, v27
    v_mfma_f32_16x16x32_bf16 v[40:43], a[168:171], a[96:99], v[40:43]
    v_and_b32 v221, 0xffff0000, v27
    v_mfma_f32_16x16x32_bf16 v[68:71], a[168:171], a[100:103], v[68:71]
    v_accvgpr_read_b32 v27, a205
    v_mfma_f32_16x16x32_bf16 v[44:47], a[172:175], a[96:99], v[44:47]
    v_lshlrev_b32 v222, 16, v27
    v_mfma_f32_16x16x32_bf16 v[72:75], a[172:175], a[100:103], v[72:75]
    v_and_b32 v223, 0xffff0000, v27
    s_waitcnt vmcnt(10) lgkmcnt(0)
    v_mfma_f32_16x16x32_bf16 v[32:35], a[176:179], a[104:107], v[32:35]
    ds_read_b128 a[160:163], v16 offset:43008
    buffer_load_dwordx4 a[152:155], v8, s[40:43], s80 offen offset:3072 sc1
    s_add_u32 s80, s80, 4096
    v_mfma_f32_16x16x32_bf16 v[60:63], a[176:179], a[108:111], v[60:63]
    ds_read_b128 a[164:167], v16 offset:44032
    buffer_load_dwordx4 a[156:159], v8, s[40:43], s81 offen offset:3072 sc1
    s_add_u32 s81, s81, 4096
    v_mfma_f32_16x16x32_bf16 v[36:39], a[180:183], a[104:107], v[36:39]
    ds_read_b128 a[168:171], v16 offset:45056
    v_accvgpr_read_b32 v27, a206
    v_mfma_f32_16x16x32_bf16 v[64:67], a[180:183], a[108:111], v[64:67]
    ds_read_b128 a[172:175], v16 offset:46080
    v_lshlrev_b32 v224, 16, v27
    v_mfma_f32_16x16x32_bf16 v[40:43], a[184:187], a[104:107], v[40:43]
    v_and_b32 v225, 0xffff0000, v27
    v_mfma_f32_16x16x32_bf16 v[68:71], a[184:187], a[108:111], v[68:71]
    v_accvgpr_read_b32 v27, a207
    v_mfma_f32_16x16x32_bf16 v[44:47], a[188:191], a[104:107], v[44:47]
    v_lshlrev_b32 v226, 16, v27
    v_mfma_f32_16x16x32_bf16 v[72:75], a[188:191], a[108:111], v[72:75]
    v_and_b32 v227, 0xffff0000, v27
    s_waitcnt vmcnt(10) lgkmcnt(0)
    v_mfma_f32_16x16x32_bf16 v[32:35], a[160:163], a[112:115], v[32:35]
    ds_read_b128 a[176:179], v16 offset:50176
    buffer_load_dwordx4 v[184:187], v8, s[40:43], s54 offen offset:2048 sc1
    v_mfma_f32_16x16x32_bf16 v[60:63], a[160:163], a[116:119], v[60:63]
    ds_read_b128 a[180:183], v16 offset:51200
    v_accvgpr_read_b32 v27, a208
    v_mfma_f32_16x16x32_bf16 v[36:39], a[164:167], a[112:115], v[36:39]
    ds_read_b128 a[184:187], v16 offset:52224
    v_lshlrev_b32 v228, 16, v27
    v_mfma_f32_16x16x32_bf16 v[64:67], a[164:167], a[116:119], v[64:67]
    ds_read_b128 a[188:191], v16 offset:53248
    v_and_b32 v229, 0xffff0000, v27
    v_mfma_f32_16x16x32_bf16 v[40:43], a[168:171], a[112:115], v[40:43]
    v_accvgpr_read_b32 v27, a209
    v_mfma_f32_16x16x32_bf16 v[68:71], a[168:171], a[116:119], v[68:71]
    v_lshlrev_b32 v230, 16, v27
    v_mfma_f32_16x16x32_bf16 v[44:47], a[172:175], a[112:115], v[44:47]
    v_and_b32 v231, 0xffff0000, v27
    v_mfma_f32_16x16x32_bf16 v[72:75], a[172:175], a[116:119], v[72:75]
    s_waitcnt vmcnt(9) lgkmcnt(0)
    v_mfma_f32_16x16x32_bf16 v[32:35], a[176:179], a[120:123], v[32:35]
    ds_read_b128 a[160:163], v17 offset:0
    buffer_load_dwordx4 v[188:191], v8, s[40:43], s54 offen offset:3072 sc1
    v_mfma_f32_16x16x32_bf16 v[60:63], a[176:179], a[124:127], v[60:63]
    ds_read_b128 a[164:167], v17 offset:1024
    v_accvgpr_read_b32 v27, a210
    v_mfma_f32_16x16x32_bf16 v[36:39], a[180:183], a[120:123], v[36:39]
    ds_read_b128 a[168:171], v17 offset:2048
    v_lshlrev_b32 v232, 16, v27
    v_mfma_f32_16x16x32_bf16 v[64:67], a[180:183], a[124:127], v[64:67]
    ds_read_b128 a[172:175], v17 offset:3072
    v_and_b32 v233, 0xffff0000, v27
    v_mfma_f32_16x16x32_bf16 v[40:43], a[184:187], a[120:123], v[40:43]
    v_accvgpr_read_b32 v27, a211
    v_mfma_f32_16x16x32_bf16 v[68:71], a[184:187], a[124:127], v[68:71]
    v_lshlrev_b32 v234, 16, v27
    v_mfma_f32_16x16x32_bf16 v[44:47], a[188:191], a[120:123], v[44:47]
    v_and_b32 v235, 0xffff0000, v27
    v_mfma_f32_16x16x32_bf16 v[72:75], a[188:191], a[124:127], v[72:75]
    s_waitcnt vmcnt(8) lgkmcnt(0)
    v_mfma_f32_16x16x32_bf16 v[32:35], a[160:163], a[128:131], v[32:35]
    ds_read_b128 a[176:179], v17 offset:7168
    buffer_load_dwordx4 v[192:195], v12, s[40:43], s54 offen offset:0 sc1
    s_add_u32 s54, s54, 20480
    v_mfma_f32_16x16x32_bf16 v[60:63], a[160:163], a[132:135], v[60:63]
    ds_read_b128 a[180:183], v17 offset:8192
    v_accvgpr_read_b32 v27, a212
    v_mfma_f32_16x16x32_bf16 v[36:39], a[164:167], a[128:131], v[36:39]
    ds_read_b128 a[184:187], v17 offset:9216
    v_lshlrev_b32 v236, 16, v27
    v_mfma_f32_16x16x32_bf16 v[64:67], a[164:167], a[132:135], v[64:67]
    ds_read_b128 a[188:191], v17 offset:10240
    v_and_b32 v237, 0xffff0000, v27
    v_mfma_f32_16x16x32_bf16 v[40:43], a[168:171], a[128:131], v[40:43]
    v_accvgpr_read_b32 v27, a213
    v_mfma_f32_16x16x32_bf16 v[68:71], a[168:171], a[132:135], v[68:71]
    v_lshlrev_b32 v238, 16, v27
    v_mfma_f32_16x16x32_bf16 v[44:47], a[172:175], a[128:131], v[44:47]
    v_and_b32 v239, 0xffff0000, v27
    v_mfma_f32_16x16x32_bf16 v[72:75], a[172:175], a[132:135], v[72:75]
    s_waitcnt vmcnt(7) lgkmcnt(0)
    v_mfma_f32_16x16x32_bf16 v[32:35], a[176:179], a[136:139], v[32:35]
    ds_read_b128 a[160:163], v17 offset:14336
    buffer_load_dwordx4 v[196:199], v8, s[40:43], s54 offen offset:0 sc1
    v_mfma_f32_16x16x32_bf16 v[60:63], a[176:179], a[140:143], v[60:63]
    ds_read_b128 a[164:167], v17 offset:15360
    v_accvgpr_read_b32 v27, a214
    v_mfma_f32_16x16x32_bf16 v[36:39], a[180:183], a[136:139], v[36:39]
    ds_read_b128 a[168:171], v17 offset:16384
    v_lshlrev_b32 v240, 16, v27
    v_mfma_f32_16x16x32_bf16 v[64:67], a[180:183], a[140:143], v[64:67]
    ds_read_b128 a[172:175], v17 offset:17408
    v_and_b32 v241, 0xffff0000, v27
    v_mfma_f32_16x16x32_bf16 v[40:43], a[184:187], a[136:139], v[40:43]
    v_accvgpr_read_b32 v27, a215
    v_mfma_f32_16x16x32_bf16 v[68:71], a[184:187], a[140:143], v[68:71]
    v_lshlrev_b32 v242, 16, v27
    v_mfma_f32_16x16x32_bf16 v[44:47], a[188:191], a[136:139], v[44:47]
    v_and_b32 v243, 0xffff0000, v27
    v_mfma_f32_16x16x32_bf16 v[72:75], a[188:191], a[140:143], v[72:75]
    s_waitcnt vmcnt(6) lgkmcnt(0)
    v_mfma_f32_16x16x32_bf16 v[32:35], a[160:163], a[144:147], v[32:35]
    ds_read_b128 a[176:179], v17 offset:21504
    buffer_load_dwordx4 v[200:203], v8, s[40:43], s54 offen offset:1024 sc1
    v_mfma_f32_16x16x32_bf16 v[60:63], a[160:163], a[148:151], v[60:63]
    ds_read_b128 a[180:183], v17 offset:22528
    v_accvgpr_read_b32 v27, a216
    v_mfma_f32_16x16x32_bf16 v[36:39], a[164:167], a[144:147], v[36:39]
    ds_read_b128 a[184:187], v17 offset:23552
    v_lshlrev_b32 v244, 16, v27
    v_mfma_f32_16x16x32_bf16 v[64:67], a[164:167], a[148:151], v[64:67]
    ds_read_b128 a[188:191], v17 offset:24576
    v_and_b32 v245, 0xffff0000, v27
    v_mfma_f32_16x16x32_bf16 v[40:43], a[168:171], a[144:147], v[40:43]
    v_accvgpr_read_b32 v27, a217
    v_mfma_f32_16x16x32_bf16 v[68:71], a[168:171], a[148:151], v[68:71]
    v_lshlrev_b32 v246, 16, v27
    v_mfma_f32_16x16x32_bf16 v[44:47], a[172:175], a[144:147], v[44:47]
    v_and_b32 v247, 0xffff0000, v27
    v_mfma_f32_16x16x32_bf16 v[72:75], a[172:175], a[148:151], v[72:75]
    s_waitcnt vmcnt(5) lgkmcnt(0)
    v_mfma_f32_16x16x32_bf16 v[32:35], a[176:179], a[152:155], v[32:35]
    ds_read_b128 a[160:163], v8 offset:4096
    buffer_load_dwordx4 v[204:207], v8, s[40:43], s54 offen offset:2048 sc1
    v_mfma_f32_16x16x32_bf16 v[60:63], a[176:179], a[156:159], v[60:63]
    ds_read_b128 a[164:167], v8 offset:5120
    v_mfma_f32_16x16x32_bf16 v[36:39], a[180:183], a[152:155], v[36:39]
    ds_read_b128 a[168:171], v8 offset:6144
    v_mfma_f32_16x16x32_bf16 v[64:67], a[180:183], a[156:159], v[64:67]
    v_mfma_f32_16x16x32_bf16 v[40:43], a[184:187], a[152:155], v[40:43]
    v_mfma_f32_16x16x32_bf16 v[68:71], a[184:187], a[156:159], v[68:71]
    v_mfma_f32_16x16x32_bf16 v[44:47], a[188:191], a[152:155], v[44:47]
    v_mfma_f32_16x16x32_bf16 v[72:75], a[188:191], a[156:159], v[72:75]
    s_lshl_b32 s98, s27, 2
    s_add_u32 s98, s98, s28
    s_mul_i32 s98, s98, 128
    s_add_u32 s98, s98, L_cS5-L_pc
    v_add_u32 v31, s98, v3
    s_bfm_b64 exec, 1, 0
    global_load_dword v4, v31, s[30:31]
    s_mov_b64 exec, -1
    s_waitcnt lgkmcnt(0)
    v_mfma_f32_16x16x32_bf16 v[48:51], a[160:163], a[0:3], 0
    ds_read_b128 a[176:179], v8 offset:11264
    buffer_load_dwordx4 v[208:211], v8, s[40:43], s54 offen offset:3072 sc1
    v_mfma_f32_16x16x32_bf16 v[76:79], a[160:163], a[4:7], 0
    ds_read_b128 a[180:183], v8 offset:12288
    v_mfma_f32_16x16x32_bf16 v[52:55], a[164:167], a[0:3], 0
    ds_read_b128 a[184:187], v8 offset:13312
    v_mfma_f32_16x16x32_bf16 v[80:83], a[164:167], a[4:7], 0
    buffer_load_dwordx4 v[212:215], v12, s[40:43], s54 offen offset:0 sc1
    s_add_u32 s54, s54, 20480
    v_mfma_f32_16x16x32_bf16 v[56:59], a[168:171], a[0:3], 0
    v_mfma_f32_16x16x32_bf16 v[84:87], a[168:171], a[4:7], 0
    s_waitcnt lgkmcnt(0)
    v_mfma_f32_16x16x32_bf16 v[48:51], a[176:179], a[8:11], v[48:51]
    ds_read_b128 a[160:163], v8 offset:18432
    v_fma_f32 v248, -v20, v128, v220
    v_fma_f32 v32, v32, v24, v248
    v_mul_f32 v248, v32, v32
    v_fma_f32 v248, v248, s61, v252
    v_mul_f32 v248, v248, v32
    v_mfma_f32_16x16x32_bf16 v[76:79], a[176:179], a[12:15], v[76:79]
    ds_read_b128 a[164:167], v8 offset:19456
    v_exp_f32 v248, v248
    v_fma_f32 v249, -v20, v129, v221
    v_fma_f32 v33, v33, v24, v249
    buffer_load_dwordx4 v[216:219], v8, s[40:43], s54 offen offset:0 sc1
    v_mfma_f32_16x16x32_bf16 v[52:55], a[180:183], a[8:11], v[52:55]
    ds_read_b128 a[168:171], v8 offset:20480
    v_mul_f32 v249, v33, v33
    v_fma_f32 v249, v249, s61, v252
    v_mul_f32 v249, v249, v33
    v_exp_f32 v249, v249
    v_mfma_f32_16x16x32_bf16 v[80:83], a[180:183], a[12:15], v[80:83]
    v_fma_f32 v250, -v20, v130, v222
    v_fma_f32 v34, v34, v24, v250
    v_mul_f32 v250, v34, v34
    buffer_load_dwordx4 a[192:195], v8, s[40:43], s54 offen offset:1024 sc1
    v_fma_f32 v250, v250, s61, v252
    v_mfma_f32_16x16x32_bf16 v[56:59], a[184:187], a[8:11], v[56:59]
    v_mul_f32 v250, v250, v34
    v_exp_f32 v250, v250
    v_fma_f32 v251, -v20, v131, v223
    v_fma_f32 v35, v35, v24, v251
    v_mfma_f32_16x16x32_bf16 v[84:87], a[184:187], a[12:15], v[84:87]
    v_mul_f32 v251, v35, v35
    v_fma_f32 v251, v251, s61, v252
    v_mul_f32 v251, v251, v35
    v_exp_f32 v251, v251
    s_waitcnt lgkmcnt(0)
    v_mfma_f32_16x16x32_bf16 v[48:51], a[160:163], a[16:19], v[48:51]
    ds_read_b128 a[176:179], v8 offset:25600
    v_add_f32 v248, 1.0, v248
    v_add_f32 v249, 1.0, v249
    v_add_f32 v250, 1.0, v250
    v_add_f32 v251, 1.0, v251
    v_rcp_f32 v248, v248
    v_mfma_f32_16x16x32_bf16 v[76:79], a[160:163], a[20:23], v[76:79]
    ds_read_b128 a[180:183], v8 offset:26624
    v_rcp_f32 v249, v249
    v_rcp_f32 v250, v250
    v_rcp_f32 v251, v251
    buffer_load_dwordx4 a[196:199], v8, s[40:43], s54 offen offset:2048 sc1
    v_mfma_f32_16x16x32_bf16 v[52:55], a[164:167], a[16:19], v[52:55]
    ds_read_b128 a[184:187], v8 offset:27648
    v_mul_f32 v32, v32, v248
    v_mul_f32 v33, v33, v249
    v_mul_f32 v34, v34, v250
    v_mul_f32 v35, v35, v251
    v_mfma_f32_16x16x32_bf16 v[80:83], a[164:167], a[20:23], v[80:83]
    v_cvt_pk_bf16_f32 v88, v32, v33
    v_cvt_pk_bf16_f32 v89, v34, v35
    v_fma_f32 v248, -v20, v132, v224
    buffer_load_dwordx4 a[200:203], v8, s[40:43], s54 offen offset:3072 sc1
    v_fma_f32 v36, v36, v24, v248
    v_mfma_f32_16x16x32_bf16 v[56:59], a[168:171], a[16:19], v[56:59]
    v_mul_f32 v248, v36, v36
    v_fma_f32 v248, v248, s61, v252
    v_mul_f32 v248, v248, v36
    v_exp_f32 v248, v248
    v_mfma_f32_16x16x32_bf16 v[84:87], a[168:171], a[20:23], v[84:87]
    v_fma_f32 v249, -v20, v133, v225
    v_fma_f32 v37, v37, v24, v249
    v_mul_f32 v249, v37, v37
    v_fma_f32 v249, v249, s61, v252
    s_waitcnt lgkmcnt(0)
    v_mfma_f32_16x16x32_bf16 v[48:51], a[176:179], a[24:27], v[48:51]
    ds_read_b128 a[160:163], v8 offset:32768
    v_mul_f32 v249, v249, v37
    v_exp_f32 v249, v249
    v_fma_f32 v250, -v20, v134, v226
    v_fma_f32 v38, v38, v24, v250
    v_mul_f32 v250, v38, v38
    v_mfma_f32_16x16x32_bf16 v[76:79], a[176:179], a[28:31], v[76:79]
    ds_read_b128 a[164:167], v8 offset:33792
    v_fma_f32 v250, v250, s61, v252
    v_mul_f32 v250, v250, v38
    v_exp_f32 v250, v250
    buffer_load_dwordx4 a[220:223], v12, s[40:43], s54 offen offset:0 sc1
    s_add_u32 s54, s54, 20480
    v_mfma_f32_16x16x32_bf16 v[52:55], a[180:183], a[24:27], v[52:55]
    ds_read_b128 a[168:171], v8 offset:34816
    v_fma_f32 v251, -v20, v135, v227
    v_fma_f32 v39, v39, v24, v251
    v_mul_f32 v251, v39, v39
    v_fma_f32 v251, v251, s61, v252
    v_mfma_f32_16x16x32_bf16 v[80:83], a[180:183], a[28:31], v[80:83]
    v_mul_f32 v251, v251, v39
    v_exp_f32 v251, v251
    v_add_f32 v248, 1.0, v248
    buffer_load_dwordx4 a[224:227], v8, s[40:43], s54 offen offset:0 sc1
    v_add_f32 v249, 1.0, v249
    v_mfma_f32_16x16x32_bf16 v[56:59], a[184:187], a[24:27], v[56:59]
    v_add_f32 v250, 1.0, v250
    v_add_f32 v251, 1.0, v251
    v_rcp_f32 v248, v248
    v_rcp_f32 v249, v249
    v_mfma_f32_16x16x32_bf16 v[84:87], a[184:187], a[28:31], v[84:87]
    v_rcp_f32 v250, v250
    v_rcp_f32 v251, v251
    v_mul_f32 v36, v36, v248
    v_mul_f32 v37, v37, v249
    s_waitcnt lgkmcnt(0)
    v_mfma_f32_16x16x32_bf16 v[48:51], a[160:163], a[32:35], v[48:51]
    ds_read_b128 a[176:179], v8 offset:39936
    v_mul_f32 v38, v38, v250
    v_mul_f32 v39, v39, v251
    v_cvt_pk_bf16_f32 v90, v36, v37
    v_cvt_pk_bf16_f32 v91, v38, v39
    buffer_store_dwordx4 v[88:91], v8, s[40:43], s56 offen offset:0 sc1
    v_mfma_f32_16x16x32_bf16 v[76:79], a[160:163], a[36:39], v[76:79]
    ds_read_b128 a[180:183], v8 offset:40960
    v_fma_f32 v248, -v21, v128, v220
    v_fma_f32 v60, v60, v25, v248
    v_mul_f32 v248, v60, v60
    buffer_load_dwordx4 a[228:231], v8, s[40:43], s54 offen offset:1024 sc1
    v_mfma_f32_16x16x32_bf16 v[52:55], a[164:167], a[32:35], v[52:55]
    ds_read_b128 a[184:187], v8 offset:41984
    v_fma_f32 v248, v248, s61, v252
    v_mul_f32 v248, v248, v60
    v_exp_f32 v248, v248
    v_fma_f32 v249, -v21, v129, v221
    v_mfma_f32_16x16x32_bf16 v[80:83], a[164:167], a[36:39], v[80:83]
    v_fma_f32 v61, v61, v25, v249
    v_mul_f32 v249, v61, v61
    v_fma_f32 v249, v249, s61, v252
    buffer_load_dwordx4 a[232:235], v8, s[40:43], s54 offen offset:2048 sc1
    v_mul_f32 v249, v249, v61
    v_mfma_f32_16x16x32_bf16 v[56:59], a[168:171], a[32:35], v[56:59]
    v_exp_f32 v249, v249
    v_fma_f32 v250, -v21, v130, v222
    v_fma_f32 v62, v62, v25, v250
    v_mul_f32 v250, v62, v62
    v_mfma_f32_16x16x32_bf16 v[84:87], a[168:171], a[36:39], v[84:87]
    v_fma_f32 v250, v250, s61, v252
    v_mul_f32 v250, v250, v62
    v_exp_f32 v250, v250
    v_fma_f32 v251, -v21, v131, v223
    s_waitcnt lgkmcnt(0)
    v_mfma_f32_16x16x32_bf16 v[48:51], a[176:179], a[40:43], v[48:51]
    ds_read_b128 a[160:163], v8 offset:47104
    v_fma_f32 v63, v63, v25, v251
    v_mul_f32 v251, v63, v63
    v_fma_f32 v251, v251, s61, v252
    v_mul_f32 v251, v251, v63
    v_exp_f32 v251, v251
    v_mfma_f32_16x16x32_bf16 v[76:79], a[176:179], a[44:47], v[76:79]
    ds_read_b128 a[164:167], v8 offset:48128
    v_add_f32 v248, 1.0, v248
    v_add_f32 v249, 1.0, v249
    v_add_f32 v250, 1.0, v250
    buffer_load_dwordx4 a[236:239], v8, s[40:43], s54 offen offset:3072 sc1
    v_mfma_f32_16x16x32_bf16 v[52:55], a[180:183], a[40:43], v[52:55]
    ds_read_b128 a[168:171], v8 offset:49152
    v_add_f32 v251, 1.0, v251
    v_rcp_f32 v248, v248
    v_rcp_f32 v249, v249
    v_rcp_f32 v250, v250
    v_mfma_f32_16x16x32_bf16 v[80:83], a[180:183], a[44:47], v[80:83]
    v_rcp_f32 v251, v251
    v_mul_f32 v60, v60, v248
    v_mul_f32 v61, v61, v249
    buffer_load_dwordx4 a[240:243], v12, s[40:43], s54 offen offset:0 sc1
    s_add_u32 s54, s54, 20480
    v_mul_f32 v62, v62, v250
    v_mfma_f32_16x16x32_bf16 v[56:59], a[184:187], a[40:43], v[56:59]
    v_mul_f32 v63, v63, v251
    v_cvt_pk_bf16_f32 v102, v60, v61
    v_cvt_pk_bf16_f32 v103, v62, v63
    v_fma_f32 v248, -v21, v132, v224
    v_mfma_f32_16x16x32_bf16 v[84:87], a[184:187], a[44:47], v[84:87]
    v_fma_f32 v64, v64, v25, v248
    v_mul_f32 v248, v64, v64
    v_fma_f32 v248, v248, s61, v252
    v_mul_f32 v248, v248, v64
    s_waitcnt lgkmcnt(0)
    v_mfma_f32_16x16x32_bf16 v[48:51], a[160:163], a[48:51], v[48:51]
    ds_read_b128 a[176:179], v8 offset:54272
    v_exp_f32 v248, v248
    v_fma_f32 v249, -v21, v133, v225
    v_fma_f32 v65, v65, v25, v249
    v_mul_f32 v249, v65, v65
    v_fma_f32 v249, v249, s61, v252
    v_mfma_f32_16x16x32_bf16 v[76:79], a[160:163], a[52:55], v[76:79]
    ds_read_b128 a[180:183], v8 offset:55296
    v_mul_f32 v249, v249, v65
    v_exp_f32 v249, v249
    v_fma_f32 v250, -v21, v134, v226
    buffer_load_dwordx4 a[244:247], v8, s[40:43], s54 offen offset:0 sc1
    v_mfma_f32_16x16x32_bf16 v[52:55], a[164:167], a[48:51], v[52:55]
    ds_read_b128 a[184:187], v8 offset:56320
    v_fma_f32 v66, v66, v25, v250
    v_mul_f32 v250, v66, v66
    v_fma_f32 v250, v250, s61, v252
    v_mul_f32 v250, v250, v66
    v_mfma_f32_16x16x32_bf16 v[80:83], a[164:167], a[52:55], v[80:83]
    v_exp_f32 v250, v250
    v_fma_f32 v251, -v21, v135, v227
    v_fma_f32 v67, v67, v25, v251
    buffer_load_dwordx4 a[248:251], v8, s[40:43], s54 offen offset:1024 sc1
    v_mul_f32 v251, v67, v67
    v_mfma_f32_16x16x32_bf16 v[56:59], a[168:171], a[48:51], v[56:59]
    v_fma_f32 v251, v251, s61, v252
    v_mul_f32 v251, v251, v67
    v_exp_f32 v251, v251
    v_add_f32 v248, 1.0, v248
    v_mfma_f32_16x16x32_bf16 v[84:87], a[168:171], a[52:55], v[84:87]
    v_add_f32 v249, 1.0, v249
    v_add_f32 v250, 1.0, v250
    v_add_f32 v251, 1.0, v251
    v_rcp_f32 v248, v248
    s_waitcnt lgkmcnt(0)
    v_mfma_f32_16x16x32_bf16 v[48:51], a[176:179], a[56:59], v[48:51]
    ds_read_b128 a[160:163], v16 offset:4096
    v_rcp_f32 v249, v249
    v_rcp_f32 v250, v250
    v_rcp_f32 v251, v251
    v_mul_f32 v64, v64, v248
    v_mul_f32 v65, v65, v249
    v_mfma_f32_16x16x32_bf16 v[76:79], a[176:179], a[60:63], v[76:79]
    ds_read_b128 a[164:167], v16 offset:5120
    v_mul_f32 v66, v66, v250
    v_mul_f32 v67, v67, v251
    v_cvt_pk_bf16_f32 v104, v64, v65
    buffer_load_dwordx4 a[252:255], v8, s[40:43], s54 offen offset:2048 sc1
    v_mfma_f32_16x16x32_bf16 v[52:55], a[180:183], a[56:59], v[52:55]
    ds_read_b128 a[168:171], v16 offset:6144
    v_cvt_pk_bf16_f32 v105, v66, v67
    buffer_store_dwordx4 v[102:105], v8, s[40:43], s57 offen offset:0 sc1
    v_fma_f32 v248, -v20, v136, v228
    v_fma_f32 v40, v40, v24, v248
    v_mfma_f32_16x16x32_bf16 v[80:83], a[180:183], a[60:63], v[80:83]
    v_mul_f32 v248, v40, v40
    v_fma_f32 v248, v248, s61, v252
    v_mul_f32 v248, v248, v40
    buffer_load_dwordx4 a[0:3], v8, s[40:43], s54 offen offset:3072 sc1
    v_exp_f32 v248, v248
    v_mfma_f32_16x16x32_bf16 v[56:59], a[184:187], a[56:59], v[56:59]
    v_fma_f32 v249, -v20, v137, v229
    v_fma_f32 v41, v41, v24, v249
    v_mul_f32 v249, v41, v41
    v_fma_f32 v249, v249, s61, v252
    v_mfma_f32_16x16x32_bf16 v[84:87], a[184:187], a[60:63], v[84:87]
    v_mul_f32 v249, v249, v41
    v_exp_f32 v249, v249
    v_fma_f32 v250, -v20, v138, v230
    v_fma_f32 v42, v42, v24, v250
    s_waitcnt lgkmcnt(0)
    v_mfma_f32_16x16x32_bf16 v[48:51], a[160:163], a[64:67], v[48:51]
    ds_read_b128 a[176:179], v16 offset:11264
    v_mul_f32 v250, v42, v42
    v_fma_f32 v250, v250, s61, v252
    v_mul_f32 v250, v250, v42
    v_exp_f32 v250, v250
    v_fma_f32 v251, -v20, v139, v231
    v_mfma_f32_16x16x32_bf16 v[76:79], a[160:163], a[68:71], v[76:79]
    ds_read_b128 a[180:183], v16 offset:12288
    v_fma_f32 v43, v43, v24, v251
    v_mul_f32 v251, v43, v43
    v_fma_f32 v251, v251, s61, v252
    buffer_load_dwordx4 a[4:7], v12, s[40:43], s54 offen offset:0 sc1
    s_add_u32 s54, s54, 20480
    v_mfma_f32_16x16x32_bf16 v[52:55], a[164:167], a[64:67], v[52:55]
    ds_read_b128 a[184:187], v16 offset:13312
    v_mul_f32 v251, v251, v43
    v_exp_f32 v251, v251
    v_add_f32 v248, 1.0, v248
    v_add_f32 v249, 1.0, v249
    v_mfma_f32_16x16x32_bf16 v[80:83], a[164:167], a[68:71], v[80:83]
    v_add_f32 v250, 1.0, v250
    v_add_f32 v251, 1.0, v251
    v_rcp_f32 v248, v248
    buffer_load_dwordx4 a[8:11], v8, s[40:43], s54 offen offset:0 sc1
    v_rcp_f32 v249, v249
    v_mfma_f32_16x16x32_bf16 v[56:59], a[168:171], a[64:67], v[56:59]
    v_rcp_f32 v250, v250
    v_rcp_f32 v251, v251
    v_mul_f32 v40, v40, v248
    v_mul_f32 v41, v41, v249
    v_mfma_f32_16x16x32_bf16 v[84:87], a[168:171], a[68:71], v[84:87]
    v_mul_f32 v42, v42, v250
    v_mul_f32 v43, v43, v251
    v_cvt_pk_bf16_f32 v92, v40, v41
    v_cvt_pk_bf16_f32 v93, v42, v43
    s_waitcnt lgkmcnt(0)
    v_mfma_f32_16x16x32_bf16 v[48:51], a[176:179], a[72:75], v[48:51]
    ds_read_b128 a[160:163], v16 offset:18432
    v_fma_f32 v248, -v20, v140, v232
    v_fma_f32 v44, v44, v24, v248
    v_mul_f32 v248, v44, v44
    v_fma_f32 v248, v248, s61, v252
    v_mul_f32 v248, v248, v44
    v_mfma_f32_16x16x32_bf16 v[76:79], a[176:179], a[76:79], v[76:79]
    ds_read_b128 a[164:167], v16 offset:19456
    v_exp_f32 v248, v248
    v_fma_f32 v249, -v20, v141, v233
    v_fma_f32 v45, v45, v24, v249
    buffer_load_dwordx4 a[12:15], v8, s[40:43], s54 offen offset:1024 sc1
    v_mfma_f32_16x16x32_bf16 v[52:55], a[180:183], a[72:75], v[52:55]
    ds_read_b128 a[168:171], v16 offset:20480
    v_mul_f32 v249, v45, v45
    v_fma_f32 v249, v249, s61, v252
    v_mul_f32 v249, v249, v45
    v_exp_f32 v249, v249
    v_mfma_f32_16x16x32_bf16 v[80:83], a[180:183], a[76:79], v[80:83]
    v_fma_f32 v250, -v20, v142, v234
    v_fma_f32 v46, v46, v24, v250
    v_mul_f32 v250, v46, v46
    buffer_load_dwordx4 a[16:19], v8, s[40:43], s54 offen offset:2048 sc1
    v_fma_f32 v250, v250, s61, v252
    v_mfma_f32_16x16x32_bf16 v[56:59], a[184:187], a[72:75], v[56:59]
    v_mul_f32 v250, v250, v46
    v_exp_f32 v250, v250
    v_fma_f32 v251, -v20, v143, v235
    v_fma_f32 v47, v47, v24, v251
    v_mfma_f32_16x16x32_bf16 v[84:87], a[184:187], a[76:79], v[84:87]
    v_mul_f32 v251, v47, v47
    v_fma_f32 v251, v251, s61, v252
    v_mul_f32 v251, v251, v47
    v_exp_f32 v251, v251
    s_waitcnt lgkmcnt(0)
    v_mfma_f32_16x16x32_bf16 v[48:51], a[160:163], a[80:83], v[48:51]
    ds_read_b128 a[176:179], v16 offset:25600
    v_add_f32 v248, 1.0, v248
    v_add_f32 v249, 1.0, v249
    v_add_f32 v250, 1.0, v250
    v_add_f32 v251, 1.0, v251
    v_rcp_f32 v248, v248
    v_mfma_f32_16x16x32_bf16 v[76:79], a[160:163], a[84:87], v[76:79]
    ds_read_b128 a[180:183], v16 offset:26624
    v_rcp_f32 v249, v249
    v_rcp_f32 v250, v250
    buffer_load_dwordx4 a[20:23], v8, s[40:43], s54 offen offset:3072 sc1
    v_rcp_f32 v251, v251
    v_mfma_f32_16x16x32_bf16 v[52:55], a[164:167], a[80:83], v[52:55]
    ds_read_b128 a[184:187], v16 offset:27648
    v_mul_f32 v44, v44, v248
    v_mul_f32 v45, v45, v249
    v_mul_f32 v46, v46, v250
    v_mul_f32 v47, v47, v251
    v_mfma_f32_16x16x32_bf16 v[80:83], a[164:167], a[84:87], v[80:83]
    v_cvt_pk_bf16_f32 v94, v44, v45
    v_cvt_pk_bf16_f32 v95, v46, v47
    buffer_store_dwordx4 v[92:95], v8, s[40:43], s56 offen offset:1024 sc1
    buffer_load_dwordx4 a[24:27], v12, s[40:43], s54 offen offset:0 sc1
    s_add_u32 s54, s54, 20480
    v_mfma_f32_16x16x32_bf16 v[56:59], a[168:171], a[80:83], v[56:59]
    v_fma_f32 v248, -v21, v136, v228
    v_fma_f32 v68, v68, v25, v248
    v_mul_f32 v248, v68, v68
    v_fma_f32 v248, v248, s61, v252
    v_mfma_f32_16x16x32_bf16 v[84:87], a[168:171], a[84:87], v[84:87]
    v_mul_f32 v248, v248, v68
    v_exp_f32 v248, v248
    v_fma_f32 v249, -v21, v137, v229
    v_fma_f32 v69, v69, v25, v249
    s_waitcnt lgkmcnt(0)
    v_mfma_f32_16x16x32_bf16 v[48:51], a[176:179], a[88:91], v[48:51]
    ds_read_b128 a[160:163], v16 offset:32768
    v_mul_f32 v249, v69, v69
    v_fma_f32 v249, v249, s61, v252
    v_mul_f32 v249, v249, v69
    v_exp_f32 v249, v249
    v_fma_f32 v250, -v21, v138, v230
    v_mfma_f32_16x16x32_bf16 v[76:79], a[176:179], a[92:95], v[76:79]
    ds_read_b128 a[164:167], v16 offset:33792
    v_fma_f32 v70, v70, v25, v250
    v_mul_f32 v250, v70, v70
    buffer_load_dwordx4 a[28:31], v8, s[40:43], s54 offen offset:0 sc1
    v_fma_f32 v250, v250, s61, v252
    v_mfma_f32_16x16x32_bf16 v[52:55], a[180:183], a[88:91], v[52:55]
    ds_read_b128 a[168:171], v16 offset:34816
    v_mul_f32 v250, v250, v70
    v_exp_f32 v250, v250
    v_fma_f32 v251, -v21, v139, v231
    v_fma_f32 v71, v71, v25, v251
    v_mfma_f32_16x16x32_bf16 v[80:83], a[180:183], a[92:95], v[80:83]
    v_mul_f32 v251, v71, v71
    v_fma_f32 v251, v251, s61, v252
    v_mul_f32 v251, v251, v71
    buffer_load_dwordx4 a[32:35], v8, s[40:43], s54 offen offset:1024 sc1
    v_mfma_f32_16x16x32_bf16 v[56:59], a[184:187], a[88:91], v[56:59]
    v_exp_f32 v251, v251
    v_add_f32 v248, 1.0, v248
    v_add_f32 v249, 1.0, v249
    v_add_f32 v250, 1.0, v250
    v_mfma_f32_16x16x32_bf16 v[84:87], a[184:187], a[92:95], v[84:87]
    v_add_f32 v251, 1.0, v251
    v_rcp_f32 v248, v248
    v_rcp_f32 v249, v249
    v_rcp_f32 v250, v250
    s_waitcnt lgkmcnt(0)
    v_mfma_f32_16x16x32_bf16 v[48:51], a[160:163], a[96:99], v[48:51]
    ds_read_b128 a[176:179], v16 offset:39936
    v_rcp_f32 v251, v251
    v_mul_f32 v68, v68, v248
    v_mul_f32 v69, v69, v249
    v_mul_f32 v70, v70, v250
    v_mul_f32 v71, v71, v251
    v_mfma_f32_16x16x32_bf16 v[76:79], a[160:163], a[100:103], v[76:79]
    ds_read_b128 a[180:183], v16 offset:40960
    v_cvt_pk_bf16_f32 v106, v68, v69
    v_cvt_pk_bf16_f32 v107, v70, v71
    buffer_load_dwordx4 a[36:39], v8, s[40:43], s54 offen offset:2048 sc1
    v_fma_f32 v248, -v21, v140, v232
    v_mfma_f32_16x16x32_bf16 v[52:55], a[164:167], a[96:99], v[52:55]
    ds_read_b128 a[184:187], v16 offset:41984
    v_fma_f32 v72, v72, v25, v248
    v_mul_f32 v248, v72, v72
    v_fma_f32 v248, v248, s61, v252
    v_mul_f32 v248, v248, v72
    v_mfma_f32_16x16x32_bf16 v[80:83], a[164:167], a[100:103], v[80:83]
    v_exp_f32 v248, v248
    v_fma_f32 v249, -v21, v141, v233
    v_fma_f32 v73, v73, v25, v249
    buffer_load_dwordx4 a[40:43], v8, s[40:43], s54 offen offset:3072 sc1
    v_mfma_f32_16x16x32_bf16 v[56:59], a[168:171], a[96:99], v[56:59]
    v_mul_f32 v249, v73, v73
    v_fma_f32 v249, v249, s61, v252
    v_mul_f32 v249, v249, v73
    v_exp_f32 v249, v249
    v_mfma_f32_16x16x32_bf16 v[84:87], a[168:171], a[100:103], v[84:87]
    v_fma_f32 v250, -v21, v142, v234
    v_fma_f32 v74, v74, v25, v250
    v_mul_f32 v250, v74, v74
    v_fma_f32 v250, v250, s61, v252
    s_waitcnt lgkmcnt(0)
    v_mfma_f32_16x16x32_bf16 v[48:51], a[176:179], a[104:107], v[48:51]
    ds_read_b128 a[160:163], v16 offset:47104
    v_mul_f32 v250, v250, v74
    v_exp_f32 v250, v250
    v_fma_f32 v251, -v21, v143, v235
    v_fma_f32 v75, v75, v25, v251
    v_mul_f32 v251, v75, v75
    v_mfma_f32_16x16x32_bf16 v[76:79], a[176:179], a[108:111], v[76:79]
    ds_read_b128 a[164:167], v16 offset:48128
    v_fma_f32 v251, v251, s61, v252
    v_mul_f32 v251, v251, v75
    buffer_load_dwordx4 a[44:47], v12, s[40:43], s54 offen offset:0 sc1
    s_add_u32 s54, s54, 20480
    v_exp_f32 v251, v251
    v_mfma_f32_16x16x32_bf16 v[52:55], a[180:183], a[104:107], v[52:55]
    ds_read_b128 a[168:171], v16 offset:49152
    v_add_f32 v248, 1.0, v248
    v_add_f32 v249, 1.0, v249
    v_add_f32 v250, 1.0, v250
    v_add_f32 v251, 1.0, v251
    v_mfma_f32_16x16x32_bf16 v[80:83], a[180:183], a[108:111], v[80:83]
    v_rcp_f32 v248, v248
    v_rcp_f32 v249, v249
    v_rcp_f32 v250, v250
    buffer_load_dwordx4 a[48:51], v8, s[40:43], s54 offen offset:0 sc1
    v_mfma_f32_16x16x32_bf16 v[56:59], a[184:187], a[104:107], v[56:59]
    v_rcp_f32 v251, v251
    v_mul_f32 v72, v72, v248
    v_mul_f32 v73, v73, v249
    v_mul_f32 v74, v74, v250
    v_mfma_f32_16x16x32_bf16 v[84:87], a[184:187], a[108:111], v[84:87]
    v_mul_f32 v75, v75, v251
    v_cvt_pk_bf16_f32 v108, v72, v73
    v_cvt_pk_bf16_f32 v109, v74, v75
    buffer_store_dwordx4 v[106:109], v8, s[40:43], s57 offen offset:1024 sc1
    s_waitcnt lgkmcnt(0)
    v_mfma_f32_16x16x32_bf16 v[48:51], a[160:163], a[112:115], v[48:51]
    ds_read_b128 a[176:179], v16 offset:54272
    buffer_load_dwordx4 a[52:55], v8, s[40:43], s54 offen offset:1024 sc1
    v_mfma_f32_16x16x32_bf16 v[76:79], a[160:163], a[116:119], v[76:79]
    ds_read_b128 a[180:183], v16 offset:55296
    v_mfma_f32_16x16x32_bf16 v[52:55], a[164:167], a[112:115], v[52:55]
    ds_read_b128 a[184:187], v16 offset:56320
    v_mfma_f32_16x16x32_bf16 v[80:83], a[164:167], a[116:119], v[80:83]
    buffer_load_dwordx4 a[56:59], v8, s[40:43], s54 offen offset:2048 sc1
    v_mfma_f32_16x16x32_bf16 v[56:59], a[168:171], a[112:115], v[56:59]
    v_mfma_f32_16x16x32_bf16 v[84:87], a[168:171], a[116:119], v[84:87]
    s_waitcnt lgkmcnt(0)
    v_mfma_f32_16x16x32_bf16 v[48:51], a[176:179], a[120:123], v[48:51]
    ds_read_b128 a[160:163], v17 offset:4096
    buffer_load_dwordx4 a[60:63], v8, s[40:43], s54 offen offset:3072 sc1
    v_mfma_f32_16x16x32_bf16 v[76:79], a[176:179], a[124:127], v[76:79]
    ds_read_b128 a[164:167], v17 offset:5120
    v_mfma_f32_16x16x32_bf16 v[52:55], a[180:183], a[120:123], v[52:55]
    ds_read_b128 a[168:171], v17 offset:6144
    v_mfma_f32_16x16x32_bf16 v[80:83], a[180:183], a[124:127], v[80:83]
    buffer_load_dwordx4 a[64:67], v12, s[40:43], s54 offen offset:0 sc1
    s_add_u32 s54, s54, 20480
    v_mfma_f32_16x16x32_bf16 v[56:59], a[184:187], a[120:123], v[56:59]
    v_mfma_f32_16x16x32_bf16 v[84:87], a[184:187], a[124:127], v[84:87]
    s_waitcnt lgkmcnt(0)
    v_mfma_f32_16x16x32_bf16 v[48:51], a[160:163], a[128:131], v[48:51]
    ds_read_b128 a[176:179], v17 offset:11264
    buffer_load_dwordx4 a[68:71], v8, s[40:43], s54 offen offset:0 sc1
    v_mfma_f32_16x16x32_bf16 v[76:79], a[160:163], a[132:135], v[76:79]
    ds_read_b128 a[180:183], v17 offset:12288
    v_mfma_f32_16x16x32_bf16 v[52:55], a[164:167], a[128:131], v[52:55]
    ds_read_b128 a[184:187], v17 offset:13312
    v_mfma_f32_16x16x32_bf16 v[80:83], a[164:167], a[132:135], v[80:83]
    buffer_load_dwordx4 a[72:75], v8, s[40:43], s54 offen offset:1024 sc1
    v_mfma_f32_16x16x32_bf16 v[56:59], a[168:171], a[128:131], v[56:59]
    v_mfma_f32_16x16x32_bf16 v[84:87], a[168:171], a[132:135], v[84:87]
    s_waitcnt lgkmcnt(0)
    v_mfma_f32_16x16x32_bf16 v[48:51], a[176:179], a[136:139], v[48:51]
    ds_read_b128 a[160:163], v17 offset:18432
    buffer_load_dwordx4 a[76:79], v8, s[40:43], s54 offen offset:2048 sc1
    v_mfma_f32_16x16x32_bf16 v[76:79], a[176:179], a[140:143], v[76:79]
    ds_read_b128 a[164:167], v17 offset:19456
    v_mfma_f32_16x16x32_bf16 v[52:55], a[180:183], a[136:139], v[52:55]
    ds_read_b128 a[168:171], v17 offset:20480
    v_mfma_f32_16x16x32_bf16 v[80:83], a[180:183], a[140:143], v[80:83]
    buffer_load_dwordx4 a[80:83], v8, s[40:43], s54 offen offset:3072 sc1
    v_mfma_f32_16x16x32_bf16 v[56:59], a[184:187], a[136:139], v[56:59]
    v_mfma_f32_16x16x32_bf16 v[84:87], a[184:187], a[140:143], v[84:87]
    s_waitcnt lgkmcnt(0)
    v_mfma_f32_16x16x32_bf16 v[48:51], a[160:163], a[144:147], v[48:51]
    ds_read_b128 a[176:179], v17 offset:25600
    buffer_load_dwordx4 a[84:87], v12, s[40:43], s54 offen offset:0 sc1
    s_add_u32 s54, s54, 20480
    v_mfma_f32_16x16x32_bf16 v[76:79], a[160:163], a[148:151], v[76:79]
    ds_read_b128 a[180:183], v17 offset:26624
    v_mfma_f32_16x16x32_bf16 v[52:55], a[164:167], a[144:147], v[52:55]
    ds_read_b128 a[184:187], v17 offset:27648
    v_mfma_f32_16x16x32_bf16 v[80:83], a[164:167], a[148:151], v[80:83]
    buffer_load_dwordx4 a[88:91], v8, s[40:43], s54 offen offset:0 sc1
    v_mfma_f32_16x16x32_bf16 v[56:59], a[168:171], a[144:147], v[56:59]
    v_mfma_f32_16x16x32_bf16 v[84:87], a[168:171], a[148:151], v[84:87]
    s_waitcnt lgkmcnt(0)
    v_mfma_f32_16x16x32_bf16 v[48:51], a[176:179], a[152:155], v[48:51]
    buffer_load_dwordx4 a[92:95], v8, s[40:43], s54 offen offset:1024 sc1
    v_mfma_f32_16x16x32_bf16 v[76:79], a[176:179], a[156:159], v[76:79]
    v_mfma_f32_16x16x32_bf16 v[52:55], a[180:183], a[152:155], v[52:55]
    v_mfma_f32_16x16x32_bf16 v[80:83], a[180:183], a[156:159], v[80:83]
    buffer_load_dwordx4 a[96:99], v8, s[40:43], s54 offen offset:2048 sc1
    v_mfma_f32_16x16x32_bf16 v[56:59], a[184:187], a[152:155], v[56:59]
    v_mfma_f32_16x16x32_bf16 v[84:87], a[184:187], a[156:159], v[84:87]
L_cS5:
    s_mov_b32 s32, s20
    s_and_b32 s33, s21, 0xffff
    s_mov_b32 s34, 2621440
    s_mov_b32 s35, 0x20000
    s_mov_b32 s36, s18
    s_and_b32 s37, s19, 0xffff
    s_mov_b32 s38, 1280
    s_mov_b32 s39, 0x20000
    s_add_u32 s3, s28, 0
    s_and_b32 s3, s3, 3
    s_lshl_b32 s99, s48, 2
    s_add_u32 s3, s3, s99
    s_mul_i32 s3, s3, 54
    s_add_u32 s3, s3, s28
    s_lshl_b32 s3, s3, 10
    s_add_u32 s3, s3, s58
    s_add_u32 s80, s3, 336896
    s_add_u32 s3, s28, 1
    s_and_b32 s3, s3, 3
    s_lshl_b32 s99, s48, 2
    s_add_u32 s3, s3, s99
    s_mul_i32 s3, s3, 54
    s_add_u32 s3, s3, s28
    s_lshl_b32 s3, s3, 10
    s_add_u32 s3, s3, s58
    s_add_u32 s81, s3, 336896
    s_add_u32 s3, s28, 2
    s_and_b32 s3, s3, 3
    s_lshl_b32 s99, s48, 2
    s_add_u32 s3, s3, s99
    s_mul_i32 s3, s3, 54
    s_add_u32 s3, s3, s28
    s_lshl_b32 s3, s3, 10
    s_add_u32 s3, s3, s58
    s_add_u32 s82, s3, 336896
    s_add_u32 s3, s28, 3
    s_and_b32 s3, s3, 3
    s_lshl_b32 s99, s48, 2
    s_add_u32 s3, s3, s99
    s_mul_i32 s3, s3, 54
    s_add_u32 s3, s3, s28
    s_lshl_b32 s3, s3, 10
    s_add_u32 s3, s3, s58
    s_add_u32 s83, s3, 336896
    v_lshlrev_b32 v28, 3, v11
    s_mul_i32 s3, s49, 160
    buffer_load_dwordx4 v[126:129], v23, s[36:39], s3 offen
    buffer_load_dwordx4 v[130:133], v23, s[36:39], s3 offen offset:64
    buffer_load_dwordx2 v[134:135], v28, s[36:39], s3 offen offset:128
    s_waitcnt vmcnt(15)
    s_barrier
    s_cmp_lg_u32 s28, 0
    s_cbranch_scc1 L_p2np
    s_lshl_b32 s3, s27, 2
    s_add_u32 s3, s3, s58
    s_add_u32 s3, s3, 336128
    s_mov_b64 exec, 1
    s_cmp_eq_u32 s79, 0
    s_cbranch_scc1 L_p2slow
    buffer_store_dword v6, v5, s[40:43], s3 offen
    s_branch L_p2pd
L_p2slow:
    buffer_store_dword v6, v5, s[40:43], s3 offen sc1
L_p2pd:
    s_mov_b64 exec, -1
L_p2np:
    v_pk_fma_f32 v[248:249], v[20:21], v[144:145], v[236:237] op_sel:[0,0,0] op_sel_hi:[0,1,1] neg_lo:[1,0,0] neg_hi:[1,0,0]
    v_pk_fma_f32 v[250:251], v[20:21], v[146:147], v[238:239] op_sel:[0,0,0] op_sel_hi:[0,1,1] neg_lo:[1,0,0] neg_hi:[1,0,0]
    v_pk_fma_f32 v[48:49], v[48:49], v[24:25], v[248:249] op_sel:[0,0,0] op_sel_hi:[1,0,1]
    v_pk_fma_f32 v[50:51], v[50:51], v[24:25], v[250:251] op_sel:[0,0,0] op_sel_hi:[1,0,1]
    v_pk_mul_f32 v[248:249], v[48:49], v[48:49]
    v_pk_mul_f32 v[250:251], v[50:51], v[50:51]
    v_pk_fma_f32 v[248:249], v[248:249], s[96:97], v[252:253]
    buffer_load_dwordx4 a[100:103], v8, s[40:43], s54 offen offset:3072 sc1
    v_pk_fma_f32 v[250:251], v[250:251], s[96:97], v[252:253]
    v_pk_mul_f32 v[248:249], v[248:249], v[48:49]
    v_pk_mul_f32 v[250:251], v[250:251], v[50:51]
    v_exp_f32 v248, v248
    v_exp_f32 v249, v249
    v_exp_f32 v250, v250
    v_exp_f32 v251, v251
    v_pk_add_f32 v[248:249], v[248:249], 1.0 op_sel_hi:[1,0]
    v_pk_add_f32 v[250:251], v[250:251], 1.0 op_sel_hi:[1,0]
    v_rcp_f32 v248, v248
    v_rcp_f32 v249, v249
    v_rcp_f32 v250, v250
    v_rcp_f32 v251, v251
    v_pk_mul_f32 v[48:49], v[48:49], v[248:249]
    v_pk_mul_f32 v[50:51], v[50:51], v[250:251]
    v_cvt_pk_bf16_f32 v96, v48, v49
    v_cvt_pk_bf16_f32 v97, v50, v51
    v_pk_fma_f32 v[248:249], v[20:21], v[148:149], v[240:241] op_sel:[0,0,0] op_sel_hi:[0,1,1] neg_lo:[1,0,0] neg_hi:[1,0,0]
    v_pk_fma_f32 v[250:251], v[20:21], v[150:151], v[242:243] op_sel:[0,0,0] op_sel_hi:[0,1,1] neg_lo:[1,0,0] neg_hi:[1,0,0]
    v_pk_fma_f32 v[52:53], v[52:53], v[24:25], v[248:249] op_sel:[0,0,0] op_sel_hi:[1,0,1]
    v_pk_fma_f32 v[54:55], v[54:55], v[24:25], v[250:251] op_sel:[0,0,0] op_sel_hi:[1,0,1]
    v_pk_mul_f32 v[248:249], v[52:53], v[52:53]
    v_pk_mul_f32 v[250:251], v[54:55], v[54:55]
    v_pk_fma_f32 v[248:249], v[248:249], s[96:97], v[252:253]
    buffer_load_dwordx4 a[104:107], v12, s[40:43], s54 offen offset:0 sc1
    s_add_u32 s54, s54, 20480
    v_pk_fma_f32 v[250:251], v[250:251], s[96:97], v[252:253]
    v_pk_mul_f32 v[248:249], v[248:249], v[52:53]
    v_pk_mul_f32 v[250:251], v[250:251], v[54:55]
    v_exp_f32 v248, v248
    v_exp_f32 v249, v249
    v_exp_f32 v250, v250
    v_exp_f32 v251, v251
    v_pk_add_f32 v[248:249], v[248:249], 1.0 op_sel_hi:[1,0]
    v_pk_add_f32 v[250:251], v[250:251], 1.0 op_sel_hi:[1,0]
    v_rcp_f32 v248, v248
    v_rcp_f32 v249, v249
    v_rcp_f32 v250, v250
    v_rcp_f32 v251, v251
    v_pk_mul_f32 v[52:53], v[52:53], v[248:249]
    v_pk_mul_f32 v[54:55], v[54:55], v[250:251]
    v_cvt_pk_bf16_f32 v98, v52, v53
    v_cvt_pk_bf16_f32 v99, v54, v55
    buffer_store_dwordx4 v[96:99], v8, s[40:43], s70 offen sc1
    v_pk_fma_f32 v[248:249], v[20:21], v[144:145], v[236:237] op_sel:[1,0,0] op_sel_hi:[1,1,1] neg_lo:[1,0,0] neg_hi:[1,0,0]
    v_pk_fma_f32 v[250:251], v[20:21], v[146:147], v[238:239] op_sel:[1,0,0] op_sel_hi:[1,1,1] neg_lo:[1,0,0] neg_hi:[1,0,0]
    v_pk_fma_f32 v[76:77], v[76:77], v[24:25], v[248:249] op_sel:[0,1,0] op_sel_hi:[1,1,1]
    v_pk_fma_f32 v[78:79], v[78:79], v[24:25], v[250:251] op_sel:[0,1,0] op_sel_hi:[1,1,1]
    v_pk_mul_f32 v[248:249], v[76:77], v[76:77]
    v_pk_mul_f32 v[250:251], v[78:79], v[78:79]
    v_pk_fma_f32 v[248:249], v[248:249], s[96:97], v[252:253]
    buffer_load_dwordx4 a[108:111], v8, s[40:43], s54 offen offset:0 sc1
    v_pk_fma_f32 v[250:251], v[250:251], s[96:97], v[252:253]
    v_pk_mul_f32 v[248:249], v[248:249], v[76:77]
    v_pk_mul_f32 v[250:251], v[250:251], v[78:79]
    v_exp_f32 v248, v248
    v_exp_f32 v249, v249
    v_exp_f32 v250, v250
    v_exp_f32 v251, v251
    v_pk_add_f32 v[248:249], v[248:249], 1.0 op_sel_hi:[1,0]
    v_pk_add_f32 v[250:251], v[250:251], 1.0 op_sel_hi:[1,0]
    v_rcp_f32 v248, v248
    v_rcp_f32 v249, v249
    v_rcp_f32 v250, v250
    v_rcp_f32 v251, v251
    v_pk_mul_f32 v[76:77], v[76:77], v[248:249]
    v_pk_mul_f32 v[78:79], v[78:79], v[250:251]
    v_cvt_pk_bf16_f32 v110, v76, v77
    v_cvt_pk_bf16_f32 v111, v78, v79
    v_pk_fma_f32 v[248:249], v[20:21], v[148:149], v[240:241] op_sel:[1,0,0] op_sel_hi:[1,1,1] neg_lo:[1,0,0] neg_hi:[1,0,0]
    v_pk_fma_f32 v[250:251], v[20:21], v[150:151], v[242:243] op_sel:[1,0,0] op_sel_hi:[1,1,1] neg_lo:[1,0,0] neg_hi:[1,0,0]
    v_pk_fma_f32 v[80:81], v[80:81], v[24:25], v[248:249] op_sel:[0,1,0] op_sel_hi:[1,1,1]
    v_pk_fma_f32 v[82:83], v[82:83], v[24:25], v[250:251] op_sel:[0,1,0] op_sel_hi:[1,1,1]
    v_pk_mul_f32 v[248:249], v[80:81], v[80:81]
    v_pk_mul_f32 v[250:251], v[82:83], v[82:83]
    v_pk_fma_f32 v[248:249], v[248:249], s[96:97], v[252:253]
    buffer_load_dwordx4 a[112:115], v8, s[40:43], s54 offen offset:1024 sc1
    v_pk_fma_f32 v[250:251], v[250:251], s[96:97], v[252:253]
    v_pk_mul_f32 v[248:249], v[248:249], v[80:81]
    v_pk_mul_f32 v[250:251], v[250:251], v[82:83]
    v_exp_f32 v248, v248
    v_exp_f32 v249, v249
    v_exp_f32 v250, v250
    v_exp_f32 v251, v251
    v_pk_add_f32 v[248:249], v[248:249], 1.0 op_sel_hi:[1,0]
    v_pk_add_f32 v[250:251], v[250:251], 1.0 op_sel_hi:[1,0]
    v_rcp_f32 v248, v248
    v_rcp_f32 v249, v249
    v_rcp_f32 v250, v250
    v_rcp_f32 v251, v251
    v_pk_mul_f32 v[80:81], v[80:81], v[248:249]
    v_pk_mul_f32 v[82:83], v[82:83], v[250:251]
    v_cvt_pk_bf16_f32 v112, v80, v81
    v_cvt_pk_bf16_f32 v113, v82, v83
    buffer_store_dwordx4 v[110:113], v8, s[40:43], s71 offen sc1
    s_add_u32 s59, s58, 336128
    buffer_load_dword v31, v10, s[40:43], s59 offen sc1
    v_pk_fma_f32 v[248:249], v[20:21], v[152:153], v[244:245] op_sel:[0,0,0] op_sel_hi:[0,1,1] neg_lo:[1,0,0] neg_hi:[1,0,0]
    v_pk_fma_f32 v[250:251], v[20:21], v[154:155], v[246:247] op_sel:[0,0,0] op_sel_hi:[0,1,1] neg_lo:[1,0,0] neg_hi:[1,0,0]
    v_pk_fma_f32 v[56:57], v[56:57], v[24:25], v[248:249] op_sel:[0,0,0] op_sel_hi:[1,0,1]
    v_pk_fma_f32 v[58:59], v[58:59], v[24:25], v[250:251] op_sel:[0,0,0] op_sel_hi:[1,0,1]
    v_pk_mul_f32 v[248:249], v[56:57], v[56:57]
    v_pk_mul_f32 v[250:251], v[58:59], v[58:59]
    v_pk_fma_f32 v[248:249], v[248:249], s[96:97], v[252:253]
    v_pk_fma_f32 v[250:251], v[250:251], s[96:97], v[252:253]
    v_pk_mul_f32 v[248:249], v[248:249], v[56:57]
    v_pk_mul_f32 v[250:251], v[250:251], v[58:59]
    v_exp_f32 v248, v248
    v_exp_f32 v249, v249
    v_exp_f32 v250, v250
    v_exp_f32 v251, v251
    v_pk_add_f32 v[248:249], v[248:249], 1.0 op_sel_hi:[1,0]
    v_pk_add_f32 v[250:251], v[250:251], 1.0 op_sel_hi:[1,0]
    v_rcp_f32 v248, v248
    v_rcp_f32 v249, v249
    v_rcp_f32 v250, v250
    v_rcp_f32 v251, v251
    v_pk_mul_f32 v[56:57], v[56:57], v[248:249]
    v_pk_mul_f32 v[58:59], v[58:59], v[250:251]
    v_cvt_pk_bf16_f32 v100, v56, v57
    v_cvt_pk_bf16_f32 v101, v58, v59
    buffer_store_dwordx2 v[100:101], v13, s[40:43], s72 offen sc1
    v_pk_fma_f32 v[248:249], v[20:21], v[152:153], v[244:245] op_sel:[1,0,0] op_sel_hi:[1,1,1] neg_lo:[1,0,0] neg_hi:[1,0,0]
    v_pk_fma_f32 v[250:251], v[20:21], v[154:155], v[246:247] op_sel:[1,0,0] op_sel_hi:[1,1,1] neg_lo:[1,0,0] neg_hi:[1,0,0]
    v_pk_fma_f32 v[84:85], v[84:85], v[24:25], v[248:249] op_sel:[0,1,0] op_sel_hi:[1,1,1]
    v_pk_fma_f32 v[86:87], v[86:87], v[24:25], v[250:251] op_sel:[0,1,0] op_sel_hi:[1,1,1]
    v_pk_mul_f32 v[248:249], v[84:85], v[84:85]
    v_pk_mul_f32 v[250:251], v[86:87], v[86:87]
    v_pk_fma_f32 v[248:249], v[248:249], s[96:97], v[252:253]
    v_pk_fma_f32 v[250:251], v[250:251], s[96:97], v[252:253]
    v_pk_mul_f32 v[248:249], v[248:249], v[84:85]
    v_pk_mul_f32 v[250:251], v[250:251], v[86:87]
    v_exp_f32 v248, v248
    v_exp_f32 v249, v249
    v_exp_f32 v250, v250
    v_exp_f32 v251, v251
    v_pk_add_f32 v[248:249], v[248:249], 1.0 op_sel_hi:[1,0]
    v_pk_add_f32 v[250:251], v[250:251], 1.0 op_sel_hi:[1,0]
    v_rcp_f32 v248, v248
    v_rcp_f32 v249, v249
    v_rcp_f32 v250, v250
    v_rcp_f32 v251, v251
    v_pk_mul_f32 v[84:85], v[84:85], v[248:249]
    v_pk_mul_f32 v[86:87], v[86:87], v[250:251]
    v_cvt_pk_bf16_f32 v114, v84, v85
    v_cvt_pk_bf16_f32 v115, v86, v87
    buffer_store_dwordx2 v[114:115], v13, s[40:43], s73 offen sc1
    s_add_u32 s3, s28, 1
    s_and_b32 s3, s3, 3
    s_mul_i32 s3, s3, 15360
    s_add_u32 s3, s3, 102400
    v_add_u32 v17, s3, v8
    s_add_u32 s3, s28, 2
    s_and_b32 s3, s3, 3
    s_mul_i32 s3, s3, 15360
    s_add_u32 s3, s3, 102400
    v_add_u32 v18, s3, v8
    s_add_u32 s3, s28, 3
    s_and_b32 s3, s3, 3
    s_mul_i32 s3, s3, 15360
    s_add_u32 s3, s3, 102400
    v_add_u32 v19, s3, v8
    s_mul_i32 s3, s28, 15360
    s_add_u32 s3, s3, 102400
    v_add_u32 v16, s3, v8
    s_waitcnt vmcnt(9)
    v_lshlrev_b32 v32, 16, v116
    v_lshlrev_b32 v27, 16, v126
    v_add_f32 v32, v32, v27
    v_and_b32 v33, 0xffff0000, v116
    v_and_b32 v27, 0xffff0000, v126
    v_add_f32 v33, v33, v27
    v_lshlrev_b32 v34, 16, v117
    v_lshlrev_b32 v27, 16, v127
    v_add_f32 v34, v34, v27
    v_and_b32 v35, 0xffff0000, v117
    v_and_b32 v27, 0xffff0000, v127
    v_add_f32 v35, v35, v27
    v_lshlrev_b32 v36, 16, v118
    v_lshlrev_b32 v27, 16, v128
    v_add_f32 v36, v36, v27
    v_and_b32 v37, 0xffff0000, v118
    v_and_b32 v27, 0xffff0000, v128
    v_add_f32 v37, v37, v27
    v_lshlrev_b32 v38, 16, v119
    v_lshlrev_b32 v27, 16, v129
    v_add_f32 v38, v38, v27
    v_and_b32 v39, 0xffff0000, v119
    v_and_b32 v27, 0xffff0000, v129
    v_add_f32 v39, v39, v27
    v_lshlrev_b32 v40, 16, v120
    v_lshlrev_b32 v27, 16, v130
    v_add_f32 v40, v40, v27
    v_and_b32 v41, 0xffff0000, v120
    v_and_b32 v27, 0xffff0000, v130
    v_add_f32 v41, v41, v27
    v_lshlrev_b32 v42, 16, v121
    v_lshlrev_b32 v27, 16, v131
    v_add_f32 v42, v42, v27
    v_and_b32 v43, 0xffff0000, v121
    v_and_b32 v27, 0xffff0000, v131
    v_add_f32 v43, v43, v27
    v_lshlrev_b32 v44, 16, v122
    v_lshlrev_b32 v27, 16, v132
    v_add_f32 v44, v44, v27
    v_and_b32 v45, 0xffff0000, v122
    v_and_b32 v27, 0xffff0000, v132
    v_add_f32 v45, v45, v27
    v_lshlrev_b32 v46, 16, v123
    v_lshlrev_b32 v27, 16, v133
    v_add_f32 v46, v46, v27
    v_and_b32 v47, 0xffff0000, v123
    v_and_b32 v27, 0xffff0000, v133
    v_add_f32 v47, v47, v27
    v_lshlrev_b32 v48, 16, v124
    v_lshlrev_b32 v27, 16, v134
    v_add_f32 v48, v48, v27
    v_and_b32 v49, 0xffff0000, v124
    v_and_b32 v27, 0xffff0000, v134
    v_add_f32 v49, v49, v27
    v_lshlrev_b32 v50, 16, v125
    v_lshlrev_b32 v27, 16, v135
    v_add_f32 v50, v50, v27
    v_and_b32 v51, 0xffff0000, v125
    v_and_b32 v27, 0xffff0000, v135
    v_add_f32 v51, v51, v27
    s_waitcnt vmcnt(2)
    s_mov_b32 s78, 0
L_c2:
    v_cmp_ne_u32 vcc, s76, v31
    s_cbranch_vccz L_c2ok
    buffer_load_dword v31, v10, s[40:43], s59 offen sc1
    s_waitcnt vmcnt(0)
    s_add_u32 s78, s78, 1
    s_cmp_lt_u32 s78, 32768
    s_cbranch_scc1 L_c2
L_c2ok:
    buffer_load_dwordx4 v[136:139], v8, s[40:43], s80 offen sc1
    s_add_u32 s80, s80, 4096
    buffer_load_dwordx4 v[140:143], v8, s[40:43], s81 offen sc1
    s_add_u32 s81, s81, 4096
    buffer_load_dwordx4 v[144:147], v8, s[40:43], s82 offen sc1
    s_add_u32 s82, s82, 4096
    buffer_load_dwordx4 v[148:151], v8, s[40:43], s83 offen sc1
    s_add_u32 s83, s83, 4096
    buffer_load_dwordx4 v[152:155], v8, s[40:43], s80 offen sc1
    s_add_u32 s80, s80, 4096
    buffer_load_dwordx4 v[220:223], v8, s[40:43], s81 offen sc1
    s_add_u32 s81, s81, 4096
    buffer_load_dwordx4 v[224:227], v8, s[40:43], s82 offen sc1
    s_add_u32 s82, s82, 4096
    buffer_load_dwordx4 v[228:231], v8, s[40:43], s83 offen sc1
    s_add_u32 s83, s83, 4096
    buffer_load_dwordx4 v[232:235], v8, s[40:43], s80 offen sc1
    s_add_u32 s80, s80, 4096
    buffer_load_dwordx4 v[236:239], v8, s[40:43], s81 offen sc1
    s_add_u32 s81, s81, 4096
    buffer_load_dwordx4 v[240:243], v8, s[40:43], s82 offen sc1
    s_add_u32 s82, s82, 4096
    buffer_load_dwordx4 v[244:247], v8, s[40:43], s83 offen sc1
    s_add_u32 s83, s83, 4096
    s_waitcnt vmcnt(12)
    s_barrier
    s_cmp_lg_u32 s28, 0
    s_cbranch_scc1 L_p3np
    s_lshl_b32 s3, s27, 2
    s_add_u32 s3, s3, s58
    s_add_u32 s3, s3, 336256
    s_mov_b64 exec, 1
    s_cmp_eq_u32 s79, 0
    s_cbranch_scc1 L_p3slow
    buffer_store_dword v6, v5, s[40:43], s3 offen
    s_branch L_p3pd
L_p3slow:
    buffer_store_dword v6, v5, s[40:43], s3 offen sc1
L_p3pd:
    s_mov_b64 exec, -1
L_p3np:
    s_waitcnt vmcnt(8)
    v_mfma_f32_16x16x32_bf16 v[32:35], v[156:159], v[136:139], v[32:35]
    buffer_load_dwordx4 v[248:251], v8, s[40:43], s80 offen sc1
    s_add_u32 s80, s80, 4096
    v_mfma_f32_16x16x32_bf16 v[36:39], v[160:163], v[136:139], v[36:39]
    v_mfma_f32_16x16x32_bf16 v[40:43], v[164:167], v[136:139], v[40:43]
    buffer_load_dwordx4 v[252:255], v8, s[40:43], s81 offen sc1
    s_add_u32 s81, s81, 4096
    v_mfma_f32_16x16x32_bf16 v[44:47], v[168:171], v[136:139], v[44:47]
    v_mfma_f32_16x16x32_bf16 v[48:51], v[172:175], v[136:139], v[48:51]
    v_mfma_f32_16x16x32_bf16 v[52:55], v[156:159], v[140:143], 0
    buffer_load_dwordx4 a[168:171], v8, s[40:43], s82 offen sc1
    s_add_u32 s82, s82, 4096
    v_mfma_f32_16x16x32_bf16 v[56:59], v[160:163], v[140:143], 0
    v_mfma_f32_16x16x32_bf16 v[60:63], v[164:167], v[140:143], 0
    buffer_load_dwordx4 a[172:175], v8, s[40:43], s83 offen sc1
    s_add_u32 s83, s83, 4096
    v_mfma_f32_16x16x32_bf16 v[64:67], v[168:171], v[140:143], 0
    v_mfma_f32_16x16x32_bf16 v[68:71], v[172:175], v[140:143], 0
    v_mfma_f32_16x16x32_bf16 v[72:75], v[156:159], v[144:147], 0
    buffer_load_dwordx4 a[176:179], v8, s[40:43], s80 offen sc1
    s_add_u32 s80, s80, 4096
    v_mfma_f32_16x16x32_bf16 v[76:79], v[160:163], v[144:147], 0
    v_mfma_f32_16x16x32_bf16 v[80:83], v[164:167], v[144:147], 0
    buffer_load_dwordx4 a[180:183], v8, s[40:43], s81 offen sc1
    s_add_u32 s81, s81, 4096
    v_mfma_f32_16x16x32_bf16 v[84:87], v[168:171], v[144:147], 0
    v_mfma_f32_16x16x32_bf16 v[88:91], v[172:175], v[144:147], 0
    v_mfma_f32_16x16x32_bf16 v[92:95], v[156:159], v[148:151], 0
    buffer_load_dwordx4 a[184:187], v8, s[40:43], s82 offen sc1
    s_add_u32 s82, s82, 4096
    v_mfma_f32_16x16x32_bf16 v[96:99], v[160:163], v[148:151], 0
    v_mfma_f32_16x16x32_bf16 v[100:103], v[164:167], v[148:151], 0
    buffer_load_dwordx4 a[188:191], v8, s[40:43], s83 offen sc1
    s_add_u32 s83, s83, 4096
    v_mfma_f32_16x16x32_bf16 v[104:107], v[168:171], v[148:151], 0
    v_mfma_f32_16x16x32_bf16 v[108:111], v[172:175], v[148:151], 0
    s_waitcnt vmcnt(12)
    v_mfma_f32_16x16x32_bf16 v[32:35], v[176:179], v[152:155], v[32:35]
    buffer_load_dwordx4 a[204:207], v8, s[40:43], s80 offen sc1
    s_add_u32 s80, s80, 4096
    v_mfma_f32_16x16x32_bf16 v[36:39], v[180:183], v[152:155], v[36:39]
    v_mfma_f32_16x16x32_bf16 v[40:43], v[184:187], v[152:155], v[40:43]
    buffer_load_dwordx4 a[208:211], v8, s[40:43], s81 offen sc1
    s_add_u32 s81, s81, 4096
    v_mfma_f32_16x16x32_bf16 v[44:47], v[188:191], v[152:155], v[44:47]
    v_mfma_f32_16x16x32_bf16 v[48:51], v[192:195], v[152:155], v[48:51]
    v_mfma_f32_16x16x32_bf16 v[52:55], v[176:179], v[220:223], v[52:55]
    buffer_load_dwordx4 a[212:215], v8, s[40:43], s82 offen sc1
    s_add_u32 s82, s82, 4096
    v_mfma_f32_16x16x32_bf16 v[56:59], v[180:183], v[220:223], v[56:59]
    v_mfma_f32_16x16x32_bf16 v[60:63], v[184:187], v[220:223], v[60:63]
    buffer_load_dwordx4 a[216:219], v8, s[40:43], s83 offen sc1
    s_add_u32 s83, s83, 4096
    v_mfma_f32_16x16x32_bf16 v[64:67], v[188:191], v[220:223], v[64:67]
    v_mfma_f32_16x16x32_bf16 v[68:71], v[192:195], v[220:223], v[68:71]
    v_mfma_f32_16x16x32_bf16 v[72:75], v[176:179], v[224:227], v[72:75]
    buffer_load_dwordx4 v[136:139], v8, s[40:43], s80 offen sc1
    s_add_u32 s80, s80, 4096
    v_mfma_f32_16x16x32_bf16 v[76:79], v[180:183], v[224:227], v[76:79]
    v_mfma_f32_16x16x32_bf16 v[80:83], v[184:187], v[224:227], v[80:83]
    buffer_load_dwordx4 v[140:143], v8, s[40:43], s81 offen sc1
    s_add_u32 s81, s81, 4096
    v_mfma_f32_16x16x32_bf16 v[84:87], v[188:191], v[224:227], v[84:87]
    v_mfma_f32_16x16x32_bf16 v[88:91], v[192:195], v[224:227], v[88:91]
    v_mfma_f32_16x16x32_bf16 v[92:95], v[176:179], v[228:231], v[92:95]
    buffer_load_dwordx4 v[144:147], v8, s[40:43], s82 offen sc1
    s_add_u32 s82, s82, 4096
    v_mfma_f32_16x16x32_bf16 v[96:99], v[180:183], v[228:231], v[96:99]
    v_mfma_f32_16x16x32_bf16 v[100:103], v[184:187], v[228:231], v[100:103]
    buffer_load_dwordx4 v[148:151], v8, s[40:43], s83 offen sc1
    s_add_u32 s83, s83, 4096
    v_mfma_f32_16x16x32_bf16 v[104:107], v[188:191], v[228:231], v[104:107]
    v_mfma_f32_16x16x32_bf16 v[108:111], v[192:195], v[228:231], v[108:111]
    s_waitcnt vmcnt(16)
    v_mfma_f32_16x16x32_bf16 v[32:35], v[196:199], v[232:235], v[32:35]
    s_add_u32 s59, s58, 336256
    buffer_load_dword v31, v10, s[40:43], s59 offen sc1
    v_mfma_f32_16x16x32_bf16 v[36:39], v[200:203], v[232:235], v[36:39]
    v_mfma_f32_16x16x32_bf16 v[40:43], v[204:207], v[232:235], v[40:43]
    v_mfma_f32_16x16x32_bf16 v[44:47], v[208:211], v[232:235], v[44:47]
    v_mfma_f32_16x16x32_bf16 v[48:51], v[212:215], v[232:235], v[48:51]
    buffer_load_dwordx4 v[152:155], v8, s[40:43], s80 offen sc1
    s_add_u32 s80, s80, 4096
    v_mfma_f32_16x16x32_bf16 v[52:55], v[196:199], v[236:239], v[52:55]
    v_mfma_f32_16x16x32_bf16 v[56:59], v[200:203], v[236:239], v[56:59]
    v_mfma_f32_16x16x32_bf16 v[60:63], v[204:207], v[236:239], v[60:63]
    v_mfma_f32_16x16x32_bf16 v[64:67], v[208:211], v[236:239], v[64:67]
    buffer_load_dwordx4 v[220:223], v8, s[40:43], s81 offen sc1
    s_add_u32 s81, s81, 4096
    v_mfma_f32_16x16x32_bf16 v[68:71], v[212:215], v[236:239], v[68:71]
    v_mfma_f32_16x16x32_bf16 v[72:75], v[196:199], v[240:243], v[72:75]
    v_mfma_f32_16x16x32_bf16 v[76:79], v[200:203], v[240:243], v[76:79]
    v_mfma_f32_16x16x32_bf16 v[80:83], v[204:207], v[240:243], v[80:83]
    buffer_load_dwordx4 v[224:227], v8, s[40:43], s82 offen sc1
    s_add_u32 s82, s82, 4096
    v_mfma_f32_16x16x32_bf16 v[84:87], v[208:211], v[240:243], v[84:87]
    v_mfma_f32_16x16x32_bf16 v[88:91], v[212:215], v[240:243], v[88:91]
    v_mfma_f32_16x16x32_bf16 v[92:95], v[196:199], v[244:247], v[92:95]
    v_mfma_f32_16x16x32_bf16 v[96:99], v[200:203], v[244:247], v[96:99]
    buffer_load_dwordx4 v[228:231], v8, s[40:43], s83 offen sc1
    s_add_u32 s83, s83, 4096
    v_mfma_f32_16x16x32_bf16 v[100:103], v[204:207], v[244:247], v[100:103]
    v_mfma_f32_16x16x32_bf16 v[104:107], v[208:211], v[244:247], v[104:107]
    v_mfma_f32_16x16x32_bf16 v[108:111], v[212:215], v[244:247], v[108:111]
    s_waitcnt vmcnt(17)
    v_mfma_f32_16x16x32_bf16 v[32:35], v[216:219], v[248:251], v[32:35]
    buffer_load_dwordx4 a[116:119], v8, s[40:43], s54 offen offset:2048 sc1
    v_mfma_f32_16x16x32_bf16 v[36:39], a[192:195], v[248:251], v[36:39]
    v_mfma_f32_16x16x32_bf16 v[40:43], a[196:199], v[248:251], v[40:43]
    v_mfma_f32_16x16x32_bf16 v[44:47], a[200:203], v[248:251], v[44:47]
    v_mfma_f32_16x16x32_bf16 v[48:51], a[220:223], v[248:251], v[48:51]
    v_mfma_f32_16x16x32_bf16 v[52:55], v[216:219], v[252:255], v[52:55]
    buffer_load_dwordx4 a[120:123], v8, s[40:43], s54 offen offset:3072 sc1
    v_mfma_f32_16x16x32_bf16 v[56:59], a[192:195], v[252:255], v[56:59]
    v_mfma_f32_16x16x32_bf16 v[60:63], a[196:199], v[252:255], v[60:63]
    v_mfma_f32_16x16x32_bf16 v[64:67], a[200:203], v[252:255], v[64:67]
    v_mfma_f32_16x16x32_bf16 v[68:71], a[220:223], v[252:255], v[68:71]
    v_mfma_f32_16x16x32_bf16 v[72:75], v[216:219], a[168:171], v[72:75]
    buffer_load_dwordx4 a[124:127], v12, s[40:43], s54 offen offset:0 sc1
    s_add_u32 s54, s54, 20480
    v_mfma_f32_16x16x32_bf16 v[76:79], a[192:195], a[168:171], v[76:79]
    v_mfma_f32_16x16x32_bf16 v[80:83], a[196:199], a[168:171], v[80:83]
    v_mfma_f32_16x16x32_bf16 v[84:87], a[200:203], a[168:171], v[84:87]
    v_mfma_f32_16x16x32_bf16 v[88:91], a[220:223], a[168:171], v[88:91]
    v_mfma_f32_16x16x32_bf16 v[92:95], v[216:219], a[172:175], v[92:95]
    buffer_load_dwordx4 a[128:131], v8, s[40:43], s54 offen offset:0 sc1
    v_mfma_f32_16x16x32_bf16 v[96:99], a[192:195], a[172:175], v[96:99]
    v_mfma_f32_16x16x32_bf16 v[100:103], a[196:199], a[172:175], v[100:103]
    v_mfma_f32_16x16x32_bf16 v[104:107], a[200:203], a[172:175], v[104:107]
    v_mfma_f32_16x16x32_bf16 v[108:111], a[220:223], a[172:175], v[108:111]
    s_waitcnt vmcnt(17)
    s_waitcnt vmcnt(8)
    s_mov_b32 s78, 0
L_c3:
    v_cmp_ne_u32 vcc, s76, v31
    s_cbranch_vccz L_c3ok
    buffer_load_dword v31, v10, s[40:43], s59 offen sc1
    s_waitcnt vmcnt(0)
    s_add_u32 s78, s78, 1
    s_cmp_lt_u32 s78, 32768
    s_cbranch_scc1 L_c3
L_c3ok:
    v_mfma_f32_16x16x32_bf16 v[32:35], a[224:227], a[176:179], v[32:35]
    buffer_load_dwordx4 v[232:235], v8, s[40:43], s80 offen sc1
    s_add_u32 s80, s80, 4096
    v_mfma_f32_16x16x32_bf16 v[36:39], a[228:231], a[176:179], v[36:39]
    v_mfma_f32_16x16x32_bf16 v[40:43], a[232:235], a[176:179], v[40:43]
    buffer_load_dwordx4 v[236:239], v8, s[40:43], s81 offen sc1
    s_add_u32 s81, s81, 4096
    v_mfma_f32_16x16x32_bf16 v[44:47], a[236:239], a[176:179], v[44:47]
    v_mfma_f32_16x16x32_bf16 v[48:51], a[240:243], a[176:179], v[48:51]
    v_mfma_f32_16x16x32_bf16 v[52:55], a[224:227], a[180:183], v[52:55]
    buffer_load_dwordx4 v[240:243], v8, s[40:43], s82 offen sc1
    s_add_u32 s82, s82, 4096
    v_mfma_f32_16x16x32_bf16 v[56:59], a[228:231], a[180:183], v[56:59]
    v_mfma_f32_16x16x32_bf16 v[60:63], a[232:235], a[180:183], v[60:63]
    buffer_load_dwordx4 v[244:247], v8, s[40:43], s83 offen sc1
    s_add_u32 s83, s83, 4096
    v_mfma_f32_16x16x32_bf16 v[64:67], a[236:239], a[180:183], v[64:67]
    v_mfma_f32_16x16x32_bf16 v[68:71], a[240:243], a[180:183], v[68:71]
    v_mfma_f32_16x16x32_bf16 v[72:75], a[224:227], a[184:187], v[72:75]
    buffer_load_dwordx4 v[248:251], v8, s[40:43], s80 offen sc1
    s_add_u32 s80, s80, 4096
    v_mfma_f32_16x16x32_bf16 v[76:79], a[228:231], a[184:187], v[76:79]
    v_mfma_f32_16x16x32_bf16 v[80:83], a[232:235], a[184:187], v[80:83]
    buffer_load_dwordx4 v[252:255], v8, s[40:43], s81 offen sc1
    s_add_u32 s81, s81, 4096
    v_mfma_f32_16x16x32_bf16 v[84:87], a[236:239], a[184:187], v[84:87]
    v_mfma_f32_16x16x32_bf16 v[88:91], a[240:243], a[184:187], v[88:91]
    v_mfma_f32_16x16x32_bf16 v[92:95], a[224:227], a[188:191], v[92:95]
    buffer_load_dwordx4 a[168:171], v8, s[40:43], s82 offen sc1
    s_add_u32 s82, s82, 4096
    v_mfma_f32_16x16x32_bf16 v[96:99], a[228:231], a[188:191], v[96:99]
    v_mfma_f32_16x16x32_bf16 v[100:103], a[232:235], a[188:191], v[100:103]
    buffer_load_dwordx4 a[172:175], v8, s[40:43], s83 offen sc1
    s_add_u32 s83, s83, 4096
    v_mfma_f32_16x16x32_bf16 v[104:107], a[236:239], a[188:191], v[104:107]
    v_mfma_f32_16x16x32_bf16 v[108:111], a[240:243], a[188:191], v[108:111]
    s_waitcnt vmcnt(21)
    v_mfma_f32_16x16x32_bf16 v[32:35], a[244:247], a[204:207], v[32:35]
    buffer_load_dwordx4 a[176:179], v8, s[40:43], s80 offen sc1
    s_add_u32 s80, s80, 4096
    v_mfma_f32_16x16x32_bf16 v[36:39], a[248:251], a[204:207], v[36:39]
    v_mfma_f32_16x16x32_bf16 v[40:43], a[252:255], a[204:207], v[40:43]
    v_mfma_f32_16x16x32_bf16 v[44:47], a[0:3], a[204:207], v[44:47]
    v_mfma_f32_16x16x32_bf16 v[48:51], a[4:7], a[204:207], v[48:51]
    v_mfma_f32_16x16x32_bf16 v[52:55], a[244:247], a[208:211], v[52:55]
    buffer_load_dwordx4 a[180:183], v8, s[40:43], s81 offen sc1
    s_add_u32 s81, s81, 4096
    v_mfma_f32_16x16x32_bf16 v[56:59], a[248:251], a[208:211], v[56:59]
    v_mfma_f32_16x16x32_bf16 v[60:63], a[252:255], a[208:211], v[60:63]
    v_mfma_f32_16x16x32_bf16 v[64:67], a[0:3], a[208:211], v[64:67]
    v_mfma_f32_16x16x32_bf16 v[68:71], a[4:7], a[208:211], v[68:71]
    v_mfma_f32_16x16x32_bf16 v[72:75], a[244:247], a[212:215], v[72:75]
    buffer_load_dwordx4 a[184:187], v8, s[40:43], s82 offen sc1
    s_add_u32 s82, s82, 4096
    v_mfma_f32_16x16x32_bf16 v[76:79], a[248:251], a[212:215], v[76:79]
    v_mfma_f32_16x16x32_bf16 v[80:83], a[252:255], a[212:215], v[80:83]
    v_mfma_f32_16x16x32_bf16 v[84:87], a[0:3], a[212:215], v[84:87]
    v_mfma_f32_16x16x32_bf16 v[88:91], a[4:7], a[212:215], v[88:91]
    v_mfma_f32_16x16x32_bf16 v[92:95], a[244:247], a[216:219], v[92:95]
    buffer_load_dwordx4 a[188:191], v8, s[40:43], s83 offen sc1
    s_add_u32 s83, s83, 4096
    v_mfma_f32_16x16x32_bf16 v[96:99], a[248:251], a[216:219], v[96:99]
    v_mfma_f32_16x16x32_bf16 v[100:103], a[252:255], a[216:219], v[100:103]
    v_mfma_f32_16x16x32_bf16 v[104:107], a[0:3], a[216:219], v[104:107]
    v_mfma_f32_16x16x32_bf16 v[108:111], a[4:7], a[216:219], v[108:111]
    s_waitcnt vmcnt(21)
    v_mfma_f32_16x16x32_bf16 v[32:35], a[8:11], v[136:139], v[32:35]
    buffer_load_dwordx4 a[204:207], v8, s[40:43], s80 offen sc1
    s_add_u32 s80, s80, 4096
    v_mfma_f32_16x16x32_bf16 v[36:39], a[12:15], v[136:139], v[36:39]
    v_mfma_f32_16x16x32_bf16 v[40:43], a[16:19], v[136:139], v[40:43]
    v_mfma_f32_16x16x32_bf16 v[44:47], a[20:23], v[136:139], v[44:47]
    v_mfma_f32_16x16x32_bf16 v[48:51], a[24:27], v[136:139], v[48:51]
    v_mfma_f32_16x16x32_bf16 v[52:55], a[8:11], v[140:143], v[52:55]
    buffer_load_dwordx4 a[208:211], v8, s[40:43], s81 offen sc1
    s_add_u32 s81, s81, 4096
    v_mfma_f32_16x16x32_bf16 v[56:59], a[12:15], v[140:143], v[56:59]
    v_mfma_f32_16x16x32_bf16 v[60:63], a[16:19], v[140:143], v[60:63]
    v_mfma_f32_16x16x32_bf16 v[64:67], a[20:23], v[140:143], v[64:67]
    v_mfma_f32_16x16x32_bf16 v[68:71], a[24:27], v[140:143], v[68:71]
    v_mfma_f32_16x16x32_bf16 v[72:75], a[8:11], v[144:147], v[72:75]
    buffer_load_dwordx4 a[212:215], v8, s[40:43], s82 offen sc1
    s_add_u32 s82, s82, 4096
    v_mfma_f32_16x16x32_bf16 v[76:79], a[12:15], v[144:147], v[76:79]
    v_mfma_f32_16x16x32_bf16 v[80:83], a[16:19], v[144:147], v[80:83]
    v_mfma_f32_16x16x32_bf16 v[84:87], a[20:23], v[144:147], v[84:87]
    v_mfma_f32_16x16x32_bf16 v[88:91], a[24:27], v[144:147], v[88:91]
    v_mfma_f32_16x16x32_bf16 v[92:95], a[8:11], v[148:151], v[92:95]
    buffer_load_dwordx4 a[216:219], v8, s[40:43], s83 offen sc1
    s_add_u32 s83, s83, 4096
    v_mfma_f32_16x16x32_bf16 v[96:99], a[12:15], v[148:151], v[96:99]
    v_mfma_f32_16x16x32_bf16 v[100:103], a[16:19], v[148:151], v[100:103]
    v_mfma_f32_16x16x32_bf16 v[104:107], a[20:23], v[148:151], v[104:107]
    v_mfma_f32_16x16x32_bf16 v[108:111], a[24:27], v[148:151], v[108:111]
    s_waitcnt vmcnt(20)
    v_mfma_f32_16x16x32_bf16 v[32:35], a[28:31], v[152:155], v[32:35]
    buffer_load_dwordx4 a[132:135], v8, s[40:43], s54 offen offset:1024 sc1
    v_mfma_f32_16x16x32_bf16 v[36:39], a[32:35], v[152:155], v[36:39]
    v_mfma_f32_16x16x32_bf16 v[40:43], a[36:39], v[152:155], v[40:43]
    buffer_load_dwordx4 a[136:139], v8, s[40:43], s54 offen offset:2048 sc1
    v_mfma_f32_16x16x32_bf16 v[44:47], a[40:43], v[152:155], v[44:47]
    v_mfma_f32_16x16x32_bf16 v[48:51], a[44:47], v[152:155], v[48:51]
    v_mfma_f32_16x16x32_bf16 v[52:55], a[28:31], v[220:223], v[52:55]
    buffer_load_dwordx4 a[140:143], v8, s[40:43], s54 offen offset:3072 sc1
    v_mfma_f32_16x16x32_bf16 v[56:59], a[32:35], v[220:223], v[56:59]
    v_mfma_f32_16x16x32_bf16 v[60:63], a[36:39], v[220:223], v[60:63]
    buffer_load_dwordx4 a[144:147], v12, s[40:43], s54 offen offset:0 sc1
    s_add_u32 s54, s54, 20480
    v_mfma_f32_16x16x32_bf16 v[64:67], a[40:43], v[220:223], v[64:67]
    v_mfma_f32_16x16x32_bf16 v[68:71], a[44:47], v[220:223], v[68:71]
    v_mfma_f32_16x16x32_bf16 v[72:75], a[28:31], v[224:227], v[72:75]
    buffer_load_dwordx4 v[136:139], v8, s[40:43], s80 offen sc1
    s_add_u32 s80, s80, 4096
    v_mfma_f32_16x16x32_bf16 v[76:79], a[32:35], v[224:227], v[76:79]
    v_mfma_f32_16x16x32_bf16 v[80:83], a[36:39], v[224:227], v[80:83]
    buffer_load_dwordx4 v[140:143], v8, s[40:43], s81 offen sc1
    s_add_u32 s81, s81, 4096
    v_mfma_f32_16x16x32_bf16 v[84:87], a[40:43], v[224:227], v[84:87]
    v_mfma_f32_16x16x32_bf16 v[88:91], a[44:47], v[224:227], v[88:91]
    v_mfma_f32_16x16x32_bf16 v[92:95], a[28:31], v[228:231], v[92:95]
    buffer_load_dwordx4 v[144:147], v8, s[40:43], s82 offen sc1
    s_add_u32 s82, s82, 4096
    v_mfma_f32_16x16x32_bf16 v[96:99], a[32:35], v[228:231], v[96:99]
    v_mfma_f32_16x16x32_bf16 v[100:103], a[36:39], v[228:231], v[100:103]
    buffer_load_dwordx4 v[148:151], v8, s[40:43], s83 offen sc1
    s_add_u32 s83, s83, 4096
    v_mfma_f32_16x16x32_bf16 v[104:107], a[40:43], v[228:231], v[104:107]
    v_mfma_f32_16x16x32_bf16 v[108:111], a[44:47], v[228:231], v[108:111]
    s_waitcnt vmcnt(20)
    v_mfma_f32_16x16x32_bf16 v[32:35], a[48:51], v[232:235], v[32:35]
    s_cmp_ge_u32 s28, 2
    s_cselect_b32 s98, 0x40000000, 0
    s_add_u32 s54, s54, s98
    buffer_load_dwordx4 a[148:151], v8, s[40:43], s54 offen offset:0 sc1
    v_mfma_f32_16x16x32_bf16 v[36:39], a[52:55], v[232:235], v[36:39]
    v_mfma_f32_16x16x32_bf16 v[40:43], a[56:59], v[232:235], v[40:43]
    buffer_load_dwordx4 a[152:155], v8, s[40:43], s54 offen offset:1024 sc1
    v_mfma_f32_16x16x32_bf16 v[44:47], a[60:63], v[232:235], v[44:47]
    v_mfma_f32_16x16x32_bf16 v[48:51], a[64:67], v[232:235], v[48:51]
    buffer_load_dwordx4 a[156:159], v8, s[40:43], s54 offen offset:2048 sc1
    v_mfma_f32_16x16x32_bf16 v[52:55], a[48:51], v[236:239], v[52:55]
    v_mfma_f32_16x16x32_bf16 v[56:59], a[52:55], v[236:239], v[56:59]
    buffer_load_dwordx4 a[160:163], v8, s[40:43], s54 offen offset:3072 sc1
    v_mfma_f32_16x16x32_bf16 v[60:63], a[56:59], v[236:239], v[60:63]
    v_mfma_f32_16x16x32_bf16 v[64:67], a[60:63], v[236:239], v[64:67]
    buffer_load_dwordx4 a[164:167], v12, s[40:43], s54 offen offset:0 sc1
    s_add_u32 s54, s54, 20480
    v_mfma_f32_16x16x32_bf16 v[68:71], a[64:67], v[236:239], v[68:71]
    v_mfma_f32_16x16x32_bf16 v[72:75], a[48:51], v[240:243], v[72:75]
    v_mfma_f32_16x16x32_bf16 v[76:79], a[52:55], v[240:243], v[76:79]
    s_cmp_ge_u32 s28, 2
    s_cselect_b32 s3, 0x40000000, 0
    s_add_u32 s80, s80, s3
    s_add_u32 s81, s81, s3
    s_add_u32 s82, s82, s3
    s_add_u32 s83, s83, s3
    buffer_load_dwordx4 v[152:155], v8, s[40:43], s80 offen sc1
    s_add_u32 s80, s80, 4096
    v_mfma_f32_16x16x32_bf16 v[80:83], a[56:59], v[240:243], v[80:83]
    v_mfma_f32_16x16x32_bf16 v[84:87], a[60:63], v[240:243], v[84:87]
    buffer_load_dwordx4 v[220:223], v8, s[40:43], s81 offen sc1
    s_add_u32 s81, s81, 4096
    v_mfma_f32_16x16x32_bf16 v[88:91], a[64:67], v[240:243], v[88:91]
    v_mfma_f32_16x16x32_bf16 v[92:95], a[48:51], v[244:247], v[92:95]
    buffer_load_dwordx4 v[224:227], v8, s[40:43], s82 offen sc1
    s_add_u32 s82, s82, 4096
    v_mfma_f32_16x16x32_bf16 v[96:99], a[52:55], v[244:247], v[96:99]
    v_mfma_f32_16x16x32_bf16 v[100:103], a[56:59], v[244:247], v[100:103]
    buffer_load_dwordx4 v[228:231], v8, s[40:43], s83 offen sc1
    s_add_u32 s83, s83, 4096
    v_mfma_f32_16x16x32_bf16 v[104:107], a[60:63], v[244:247], v[104:107]
    v_mfma_f32_16x16x32_bf16 v[108:111], a[64:67], v[244:247], v[108:111]
    s_waitcnt vmcnt(25)
    v_mfma_f32_16x16x32_bf16 v[32:35], a[68:71], v[248:251], v[32:35]
    v_mfma_f32_16x16x32_bf16 v[36:39], a[72:75], v[248:251], v[36:39]
    v_mfma_f32_16x16x32_bf16 v[40:43], a[76:79], v[248:251], v[40:43]
    v_mfma_f32_16x16x32_bf16 v[44:47], a[80:83], v[248:251], v[44:47]
    v_mfma_f32_16x16x32_bf16 v[48:51], a[84:87], v[248:251], v[48:51]
    v_mfma_f32_16x16x32_bf16 v[52:55], a[68:71], v[252:255], v[52:55]
    v_mfma_f32_16x16x32_bf16 v[56:59], a[72:75], v[252:255], v[56:59]
    v_mfma_f32_16x16x32_bf16 v[60:63], a[76:79], v[252:255], v[60:63]
    v_mfma_f32_16x16x32_bf16 v[64:67], a[80:83], v[252:255], v[64:67]
    v_mfma_f32_16x16x32_bf16 v[68:71], a[84:87], v[252:255], v[68:71]
    v_mfma_f32_16x16x32_bf16 v[72:75], a[68:71], a[168:171], v[72:75]
    v_mfma_f32_16x16x32_bf16 v[76:79], a[72:75], a[168:171], v[76:79]
    v_mfma_f32_16x16x32_bf16 v[80:83], a[76:79], a[168:171], v[80:83]
    v_mfma_f32_16x16x32_bf16 v[84:87], a[80:83], a[168:171], v[84:87]
    v_mfma_f32_16x16x32_bf16 v[88:91], a[84:87], a[168:171], v[88:91]
    v_mfma_f32_16x16x32_bf16 v[92:95], a[68:71], a[172:175], v[92:95]
    v_mfma_f32_16x16x32_bf16 v[96:99], a[72:75], a[172:175], v[96:99]
    v_mfma_f32_16x16x32_bf16 v[100:103], a[76:79], a[172:175], v[100:103]
    v_mfma_f32_16x16x32_bf16 v[104:107], a[80:83], a[172:175], v[104:107]
    v_mfma_f32_16x16x32_bf16 v[108:111], a[84:87], a[172:175], v[108:111]
    s_waitcnt vmcnt(21)
    v_mfma_f32_16x16x32_bf16 v[32:35], a[88:91], a[176:179], v[32:35]
    v_mfma_f32_16x16x32_bf16 v[36:39], a[92:95], a[176:179], v[36:39]
    v_mfma_f32_16x16x32_bf16 v[40:43], a[96:99], a[176:179], v[40:43]
    v_mfma_f32_16x16x32_bf16 v[44:47], a[100:103], a[176:179], v[44:47]
    v_mfma_f32_16x16x32_bf16 v[48:51], a[104:107], a[176:179], v[48:51]
    v_mfma_f32_16x16x32_bf16 v[52:55], a[88:91], a[180:183], v[52:55]
    v_mfma_f32_16x16x32_bf16 v[56:59], a[92:95], a[180:183], v[56:59]
    v_mfma_f32_16x16x32_bf16 v[60:63], a[96:99], a[180:183], v[60:63]
    v_mfma_f32_16x16x32_bf16 v[64:67], a[100:103], a[180:183], v[64:67]
    v_mfma_f32_16x16x32_bf16 v[68:71], a[104:107], a[180:183], v[68:71]
    v_mfma_f32_16x16x32_bf16 v[72:75], a[88:91], a[184:187], v[72:75]
    v_mfma_f32_16x16x32_bf16 v[76:79], a[92:95], a[184:187], v[76:79]
    v_mfma_f32_16x16x32_bf16 v[80:83], a[96:99], a[184:187], v[80:83]
    v_mfma_f32_16x16x32_bf16 v[84:87], a[100:103], a[184:187], v[84:87]
    v_mfma_f32_16x16x32_bf16 v[88:91], a[104:107], a[184:187], v[88:91]
    v_mfma_f32_16x16x32_bf16 v[92:95], a[88:91], a[188:191], v[92:95]
    v_mfma_f32_16x16x32_bf16 v[96:99], a[92:95], a[188:191], v[96:99]
    v_mfma_f32_16x16x32_bf16 v[100:103], a[96:99], a[188:191], v[100:103]
    v_mfma_f32_16x16x32_bf16 v[104:107], a[100:103], a[188:191], v[104:107]
    v_mfma_f32_16x16x32_bf16 v[108:111], a[104:107], a[188:191], v[108:111]
    s_waitcnt vmcnt(17)
    v_mfma_f32_16x16x32_bf16 v[32:35], a[108:111], a[204:207], v[32:35]
    v_mfma_f32_16x16x32_bf16 v[36:39], a[112:115], a[204:207], v[36:39]
    v_mfma_f32_16x16x32_bf16 v[40:43], a[116:119], a[204:207], v[40:43]
    v_mfma_f32_16x16x32_bf16 v[44:47], a[120:123], a[204:207], v[44:47]
    v_mfma_f32_16x16x32_bf16 v[48:51], a[124:127], a[204:207], v[48:51]
    v_mfma_f32_16x16x32_bf16 v[52:55], a[108:111], a[208:211], v[52:55]
    v_mfma_f32_16x16x32_bf16 v[56:59], a[112:115], a[208:211], v[56:59]
    v_mfma_f32_16x16x32_bf16 v[60:63], a[116:119], a[208:211], v[60:63]
    v_mfma_f32_16x16x32_bf16 v[64:67], a[120:123], a[208:211], v[64:67]
    v_mfma_f32_16x16x32_bf16 v[68:71], a[124:127], a[208:211], v[68:71]
    v_mfma_f32_16x16x32_bf16 v[72:75], a[108:111], a[212:215], v[72:75]
    v_mfma_f32_16x16x32_bf16 v[76:79], a[112:115], a[212:215], v[76:79]
    v_mfma_f32_16x16x32_bf16 v[80:83], a[116:119], a[212:215], v[80:83]
    v_mfma_f32_16x16x32_bf16 v[84:87], a[120:123], a[212:215], v[84:87]
    v_mfma_f32_16x16x32_bf16 v[88:91], a[124:127], a[212:215], v[88:91]
    v_mfma_f32_16x16x32_bf16 v[92:95], a[108:111], a[216:219], v[92:95]
    v_mfma_f32_16x16x32_bf16 v[96:99], a[112:115], a[216:219], v[96:99]
    v_mfma_f32_16x16x32_bf16 v[100:103], a[116:119], a[216:219], v[100:103]
    v_mfma_f32_16x16x32_bf16 v[104:107], a[120:123], a[216:219], v[104:107]
    v_mfma_f32_16x16x32_bf16 v[108:111], a[124:127], a[216:219], v[108:111]
    s_waitcnt vmcnt(9)
    v_mfma_f32_16x16x32_bf16 v[32:35], a[128:131], v[136:139], v[32:35]
    v_mfma_f32_16x16x32_bf16 v[36:39], a[132:135], v[136:139], v[36:39]
    v_mfma_f32_16x16x32_bf16 v[40:43], a[136:139], v[136:139], v[40:43]
    v_mfma_f32_16x16x32_bf16 v[44:47], a[140:143], v[136:139], v[44:47]
    v_mfma_f32_16x16x32_bf16 v[48:51], a[144:147], v[136:139], v[48:51]
    v_mfma_f32_16x16x32_bf16 v[52:55], a[128:131], v[140:143], v[52:55]
    v_mfma_f32_16x16x32_bf16 v[56:59], a[132:135], v[140:143], v[56:59]
    v_mfma_f32_16x16x32_bf16 v[60:63], a[136:139], v[140:143], v[60:63]
    v_mfma_f32_16x16x32_bf16 v[64:67], a[140:143], v[140:143], v[64:67]
    v_mfma_f32_16x16x32_bf16 v[68:71], a[144:147], v[140:143], v[68:71]
    v_mfma_f32_16x16x32_bf16 v[72:75], a[128:131], v[144:147], v[72:75]
    v_mfma_f32_16x16x32_bf16 v[76:79], a[132:135], v[144:147], v[76:79]
    v_mfma_f32_16x16x32_bf16 v[80:83], a[136:139], v[144:147], v[80:83]
    v_mfma_f32_16x16x32_bf16 v[84:87], a[140:143], v[144:147], v[84:87]
    v_mfma_f32_16x16x32_bf16 v[88:91], a[144:147], v[144:147], v[88:91]
    v_mfma_f32_16x16x32_bf16 v[92:95], a[128:131], v[148:151], v[92:95]
    v_mfma_f32_16x16x32_bf16 v[96:99], a[132:135], v[148:151], v[96:99]
    v_mfma_f32_16x16x32_bf16 v[100:103], a[136:139], v[148:151], v[100:103]
    v_mfma_f32_16x16x32_bf16 v[104:107], a[140:143], v[148:151], v[104:107]
    v_mfma_f32_16x16x32_bf16 v[108:111], a[144:147], v[148:151], v[108:111]
    s_waitcnt vmcnt(0)
    v_mfma_f32_16x16x32_bf16 v[52:55], a[148:151], v[220:223], v[52:55]
    v_mfma_f32_16x16x32_bf16 v[56:59], a[152:155], v[220:223], v[56:59]
    v_mfma_f32_16x16x32_bf16 v[60:63], a[156:159], v[220:223], v[60:63]
    v_mfma_f32_16x16x32_bf16 v[64:67], a[160:163], v[220:223], v[64:67]
    v_mfma_f32_16x16x32_bf16 v[68:71], a[164:167], v[220:223], v[68:71]
    v_mfma_f32_16x16x32_bf16 v[72:75], a[148:151], v[224:227], v[72:75]
    s_nop 2
    ds_write_b128 v17, v[52:55] offset:0
    v_mfma_f32_16x16x32_bf16 v[76:79], a[152:155], v[224:227], v[76:79]
    ds_write_b128 v17, v[56:59] offset:1024
    v_mfma_f32_16x16x32_bf16 v[80:83], a[156:159], v[224:227], v[80:83]
    ds_write_b128 v17, v[60:63] offset:2048
    v_mfma_f32_16x16x32_bf16 v[84:87], a[160:163], v[224:227], v[84:87]
    ds_write_b128 v17, v[64:67] offset:3072
    v_mfma_f32_16x16x32_bf16 v[88:91], a[164:167], v[224:227], v[88:91]
    ds_write_b128 v17, v[68:71] offset:4096
    v_mfma_f32_16x16x32_bf16 v[92:95], a[148:151], v[228:231], v[92:95]
    ds_write_b128 v18, v[72:75] offset:5120
    v_mfma_f32_16x16x32_bf16 v[96:99], a[152:155], v[228:231], v[96:99]
    ds_write_b128 v18, v[76:79] offset:6144
    v_mfma_f32_16x16x32_bf16 v[100:103], a[156:159], v[228:231], v[100:103]
    ds_write_b128 v18, v[80:83] offset:7168
    v_mfma_f32_16x16x32_bf16 v[104:107], a[160:163], v[228:231], v[104:107]
    ds_write_b128 v18, v[84:87] offset:8192
    v_mfma_f32_16x16x32_bf16 v[108:111], a[164:167], v[228:231], v[108:111]
    ds_write_b128 v18, v[88:91] offset:9216
    v_mfma_f32_16x16x32_bf16 v[32:35], a[148:151], v[152:155], v[32:35]
    ds_write_b128 v19, v[92:95] offset:10240
    v_mfma_f32_16x16x32_bf16 v[36:39], a[152:155], v[152:155], v[36:39]
    ds_write_b128 v19, v[96:99] offset:11264
    v_mfma_f32_16x16x32_bf16 v[40:43], a[156:159], v[152:155], v[40:43]
    ds_write_b128 v19, v[100:103] offset:12288
    v_mfma_f32_16x16x32_bf16 v[44:47], a[160:163], v[152:155], v[44:47]
    ds_write_b128 v19, v[104:107] offset:13312
    v_mfma_f32_16x16x32_bf16 v[48:51], a[164:167], v[152:155], v[48:51]
    ds_write_b128 v19, v[108:111] offset:14336
    s_waitcnt lgkmcnt(0)
    s_barrier
    ds_read_b128 v[52:55], v16 offset:0
    ds_read_b128 v[72:75], v16 offset:5120
    ds_read_b128 v[92:95], v16 offset:10240
    ds_read_b128 v[56:59], v16 offset:1024
    ds_read_b128 v[76:79], v16 offset:6144
    ds_read_b128 v[96:99], v16 offset:11264
    ds_read_b128 v[60:63], v16 offset:2048
    ds_read_b128 v[80:83], v16 offset:7168
    ds_read_b128 v[100:103], v16 offset:12288
    ds_read_b128 v[64:67], v16 offset:3072
    ds_read_b128 v[84:87], v16 offset:8192
    ds_read_b128 v[104:107], v16 offset:13312
    ds_read_b128 v[68:71], v16 offset:4096
    ds_read_b128 v[88:91], v16 offset:9216
    ds_read_b128 v[108:111], v16 offset:14336
    s_waitcnt lgkmcnt(12)
    v_pk_add_f32 v[52:53], v[52:53], v[72:73]
    v_pk_add_f32 v[32:33], v[32:33], v[92:93]
    v_pk_add_f32 v[54:55], v[54:55], v[74:75]
    v_pk_add_f32 v[34:35], v[34:35], v[94:95]
    v_pk_add_f32 v[32:33], v[32:33], v[52:53]
    v_pk_add_f32 v[34:35], v[34:35], v[54:55]
    v_cvt_pk_bf16_f32 v116, v32, v33
    v_cvt_pk_bf16_f32 v117, v34, v35
    s_waitcnt lgkmcnt(9)
    v_pk_add_f32 v[56:57], v[56:57], v[76:77]
    v_pk_add_f32 v[36:37], v[36:37], v[96:97]
    v_pk_add_f32 v[58:59], v[58:59], v[78:79]
    v_pk_add_f32 v[38:39], v[38:39], v[98:99]
    v_pk_add_f32 v[36:37], v[36:37], v[56:57]
    v_pk_add_f32 v[38:39], v[38:39], v[58:59]
    v_cvt_pk_bf16_f32 v118, v36, v37
    v_cvt_pk_bf16_f32 v119, v38, v39
    s_waitcnt lgkmcnt(6)
    v_pk_add_f32 v[60:61], v[60:61], v[80:81]
    v_pk_add_f32 v[40:41], v[40:41], v[100:101]
    v_pk_add_f32 v[62:63], v[62:63], v[82:83]
    v_pk_add_f32 v[42:43], v[42:43], v[102:103]
    v_pk_add_f32 v[40:41], v[40:41], v[60:61]
    v_pk_add_f32 v[42:43], v[42:43], v[62:63]
    v_cvt_pk_bf16_f32 v120, v40, v41
    v_cvt_pk_bf16_f32 v121, v42, v43
    s_waitcnt lgkmcnt(3)
    v_pk_add_f32 v[64:65], v[64:65], v[84:85]
    v_pk_add_f32 v[44:45], v[44:45], v[104:105]
    v_pk_add_f32 v[66:67], v[66:67], v[86:87]
    v_pk_add_f32 v[46:47], v[46:47], v[106:107]
    v_pk_add_f32 v[44:45], v[44:45], v[64:65]
    v_pk_add_f32 v[46:47], v[46:47], v[66:67]
    v_cvt_pk_bf16_f32 v122, v44, v45
    v_cvt_pk_bf16_f32 v123, v46, v47
    s_waitcnt lgkmcnt(0)
    v_pk_add_f32 v[68:69], v[68:69], v[88:89]
    v_pk_add_f32 v[48:49], v[48:49], v[108:109]
    v_pk_add_f32 v[70:71], v[70:71], v[90:91]
    v_pk_add_f32 v[50:51], v[50:51], v[110:111]
    v_pk_add_f32 v[48:49], v[48:49], v[68:69]
    v_pk_add_f32 v[50:51], v[50:51], v[70:71]
    v_cvt_pk_bf16_f32 v124, v48, v49
    v_cvt_pk_bf16_f32 v125, v50, v51
    buffer_store_dwordx4 v[116:119], v14, s[32:35], s51 offen
    buffer_store_dwordx4 v[120:123], v14, s[32:35], s51 offen offset:64
    buffer_store_dwordx2 v[124:125], v15, s[32:35], s51 offen offset:128
    s_or_b32 s3, s2, s28
    s_cmp_lg_u32 s3, 0
    s_cbranch_scc1 L_notagclr
    global_store_dword v5, v5, s[22:23] sc1
L_notagclr:
L_end:
    s_endpgm
.p2align 6
T1_tab:
.short 128,144,160,176,192,208,224,240,384,400,416,432,448,464,480,496,640,656,672,688,704,720,736,752,896,912,928,944,960,976,992,1008,1024,1040,1056,1072,1088,1104,1120,1136,1152,1168,1184,1200,1280,1296,1312,1328,1344,1360,1376,1392,1408,1424,1440,1456,1536,1552,1568,1584,1600,1616,1632,1648,1664,1680,1696,1712,1792,1808,1824,1840,1856,1872,1888,1904,1920,1936,1952,1968,2176,2192,2208,2224,2240,2256,2272,2288,3072,3088,3104,3120,3136,3152,3168,3184,3200,3216,3232,3248,3520,3536,3552,3568,3776,3792,3808,3824,4032,4048,4064,4080,4352,4368,4384,4400,4416,4432,4448,4464,4480,4496,4512,4528,4544,4560,4576,4592,4608,4624,4640,4656,4672,4688,4704,4720,4736,4752,4768,4784,4800,4816,4832,4848,4864,4880,4896,4912,4928,4944,4960,4976,4992,5008,5024,5040,5056,5072,5088,5104,5312,5328,5344,5360,5568,5584,5600,5616,6144,6160,6176,6192,6208,6224,6240,6256,6272,6288,6304,6320,6336,6352,6368,6384,6400,6416,6432,6448,6464,6480,6496,6512,6528,6544,6560,6576,6592,6608,6624,6640,7168,7424,7680,7936,8192,8448,8704,8960,9216,9472,0,0,0,0,0,0,0,0,0,0,0,0,0,0,0,0,0,0,0,0,0,0,0,0,0,0,0,0,0,0,0,0,0,0,0,0,0,0,0,0,0,0,0,0,0,0
T2_tab:
.short 0,640,2040,32,672,2040,2040,2040,1408,1600,1632,2040,0,0,0,0
.short 8,648,2040,40,680,2040,2040,2040,1416,2040,2040,1664,0,0,0,0
.short 16,656,2040,48,688,2040,2040,2040,1424,1600,1632,2040,0,0,0,0
.short 24,664,2040,56,696,2040,2040,2040,1432,2040,2040,1664,0,0,0,0
.short 256,704,2040,288,736,2040,2040,2040,1440,1600,1632,2040,0,0,0,0
.short 264,712,2040,296,744,2040,2040,2040,1448,2040,2040,1664,0,0,0,0
.short 272,720,2040,304,752,2040,2040,2040,1456,1600,1632,2040,0,0,0,0
.short 280,728,2040,312,760,2040,2040,2040,1464,2040,2040,1664,0,0,0,0
.short 320,768,2040,2040,2040,1280,2040,2040,2040,1600,1632,2040,0,0,0,0
.short 328,776,2040,2040,2040,1288,2040,2040,2040,2040,2040,1664,0,0,0,0
.short 336,784,2040,2040,2040,1296,2040,2040,2040,1600,1632,2040,0,0,0,0
.short 344,792,2040,2040,2040,1304,2040,2040,2040,2040,2040,1664,0,0,0,0
.short 2040,2040,1344,2040,2040,1376,2040,2040,2040,1600,1632,2040,0,0,0,0
.short 2040,2040,1352,2040,2040,1384,2040,2040,2040,2040,2040,1664,0,0,0,0
.short 2040,2040,1360,2040,2040,1392,2040,2040,2040,1600,1632,2040,0,0,0,0
.short 2040,2040,1368,2040,2040,1400,2040,2040,2040,2040,2040,1664,0,0,0,0
.short 64,2040,2040,96,2040,2040,2040,960,1536,1608,2040,2040,0,0,0,0
.short 72,2040,2040,104,2040,2040,2040,968,1544,2040,1640,1672,0,0,0,0
.short 80,2040,2040,112,2040,2040,2040,976,1552,1608,2040,2040,0,0,0,0
.short 88,2040,2040,120,2040,2040,2040,984,1560,2040,1640,1672,0,0,0,0
.short 352,2040,2040,384,2040,2040,2040,992,1568,1608,2040,2040,0,0,0,0
.short 360,2040,2040,392,2040,2040,2040,1000,1576,2040,1640,1672,0,0,0,0
.short 368,2040,2040,400,2040,2040,2040,1008,1584,1608,2040,2040,0,0,0,0
.short 376,2040,2040,408,2040,2040,2040,1016,1592,2040,1640,1672,0,0,0,0
.short 416,2040,2040,2040,800,1312,2040,2040,2040,1608,2040,2040,0,0,0,0
.short 424,2040,2040,2040,808,1320,2040,2040,2040,2040,1640,1672,0,0,0,0
.short 432,2040,2040,2040,816,1328,2040,2040,2040,1608,2040,2040,0,0,0,0
.short 440,2040,2040,2040,824,1336,2040,2040,2040,2040,1640,1672,0,0,0,0
.short 2040,896,1472,2040,928,1504,2040,2040,2040,1608,2040,2040,0,0,0,0
.short 2040,904,1480,2040,936,1512,2040,2040,2040,2040,1640,1672,0,0,0,0
.short 2040,912,1488,2040,944,1520,2040,2040,2040,1608,2040,2040,0,0,0,0
.short 2040,920,1496,2040,952,1528,2040,2040,2040,2040,1640,1672,0,0,0,0
.short 128,2040,2040,160,2040,2040,2040,1088,2040,1616,2040,2040,0,0,0,0
.short 136,2040,2040,168,2040,2040,2040,1096,2040,2040,1648,2040,0,0,0,0
.short 144,2040,2040,176,2040,2040,2040,1104,2040,1616,2040,2040,0,0,0,0
.short 152,2040,2040,184,2040,2040,2040,1112,2040,2040,1648,2040,0,0,0,0
.short 448,2040,2040,480,2040,2040,2040,1120,2040,1616,2040,2040,0,0,0,0
.short 456,2040,2040,488,2040,2040,2040,1128,2040,2040,1648,2040,0,0,0,0
.short 464,2040,2040,496,2040,2040,2040,1136,2040,1616,2040,2040,0,0,0,0
.short 472,2040,2040,504,2040,2040,2040,1144,2040,2040,1648,2040,0,0,0,0
.short 512,2040,2040,2040,832,2040,2040,2040,2040,1616,2040,2040,0,0,0,0
.short 520,2040,2040,2040,840,2040,2040,2040,2040,2040,1648,2040,0,0,0,0
.short 528,2040,2040,2040,848,2040,2040,2040,2040,1616,2040,2040,0,0,0,0
.short 536,2040,2040,2040,856,2040,2040,2040,2040,2040,1648,2040,0,0,0,0
.short 2040,1024,2040,2040,1056,2040,2040,2040,2040,1616,2040,2040,0,0,0,0
.short 2040,1032,2040,2040,1064,2040,2040,2040,2040,2040,1648,2040,0,0,0,0
.short 2040,1040,2040,2040,1072,2040,2040,2040,2040,1616,2040,2040,0,0,0,0
.short 2040,1048,2040,2040,1080,2040,2040,2040,2040,2040,1648,2040,0,0,0,0
.short 192,2040,2040,224,2040,2040,2040,1216,2040,1624,2040,2040,0,0,0,0
.short 200,2040,2040,232,2040,2040,2040,1224,2040,2040,1656,2040,0,0,0,0
.short 208,2040,2040,240,2040,2040,2040,1232,2040,1624,2040,2040,0,0,0,0
.short 216,2040,2040,248,2040,2040,2040,1240,2040,2040,1656,2040,0,0,0,0
.short 544,2040,2040,576,2040,2040,2040,1248,2040,1624,2040,2040,0,0,0,0
.short 552,2040,2040,584,2040,2040,2040,1256,2040,2040,1656,2040,0,0,0,0
.short 560,2040,2040,592,2040,2040,2040,1264,2040,1624,2040,2040,0,0,0,0
.short 568,2040,2040,600,2040,2040,2040,1272,2040,2040,1656,2040,0,0,0,0
.short 608,2040,2040,2040,864,2040,2040,2040,2040,1624,2040,2040,0,0,0,0
.short 616,2040,2040,2040,872,2040,2040,2040,2040,2040,1656,2040,0,0,0,0
.short 624,2040,2040,2040,880,2040,2040,2040,2040,1624,2040,2040,0,0,0,0
.short 632,2040,2040,2040,888,2040,2040,2040,2040,2040,1656,2040,0,0,0,0
.short 2040,1152,2040,2040,1184,2040,2040,2040,2040,1624,2040,2040,0,0,0,0
.short 2040,1160,2040,2040,1192,2040,2040,2040,2040,2040,1656,2040,0,0,0,0
.short 2040,1168,2040,2040,1200,2040,2040,2040,2040,1624,2040,2040,0,0,0,0
.short 2040,1176,2040,2040,1208,2040,2040,2040,2040,2040,1656,2040,0,0,0,0
.fill 2048, 4, 0
.section .rodata,"a"
.p2align 6
.amdhsa_kernel sequential_preLN__linear_attn_block__mixer_channel_mlp__prompt_kernel
  .amdhsa_next_free_vgpr 512
  .amdhsa_next_free_sgpr 102
  .amdhsa_accum_offset 256
  .amdhsa_group_segment_fixed_size 0
  .amdhsa_kernarg_size 88
  .amdhsa_user_sgpr_count 2
  .amdhsa_user_sgpr_kernarg_segment_ptr 1
  .amdhsa_system_sgpr_workgroup_id_x 1
.end_amdhsa_kernel
```
